```python
import torch

def _softmax(x, axis=-1):
    return torch.softmax(x, dim=axis)

def _gelu(x):
    return torch.nn.functional.gelu(x, approximate='tanh')

def _silu(x):
    return torch.nn.functional.silu(x)

def _sigmoid(x):
    return torch.sigmoid(x)

def _layernorm(x, axis=-1, eps=1e-05):
    m = x.mean(dim=axis, keepdim=True)
    v = x.var(dim=axis, keepdim=True, unbiased=False)
    return (x - m) / torch.sqrt(v + eps)

def _scatter_add(tgt, idx, src, axis=0):
    return tgt.clone().index_add_(axis, idx, src)

def _segment_sum(src, seg, n):
    out = torch.zeros((n,) + src.shape[1:], dtype=src.dtype)
    return out.index_add_(0, seg, src)

def _pad(x, pw):
    flat = tuple((v for pair in reversed(pw) for v in pair))
    return torch.nn.functional.pad(x, flat)
kernel_name = 'gather_scatter__tensor_product_equiv_equiformer__graph'

def setup_inputs():

    _w = lambda a: (lambda t: t.to(torch.bfloat16) if t.is_floating_point() else t)(torch.as_tensor(a))
    N, deg, C, De = (10000, 64, 64, max(0, 1))
    E = N * deg
    src = (lambda lo, hi, *s: torch.randint(lo, hi, s))(0, N, E).to(torch.int64)
    dst = (lambda lo, hi, *s: torch.randint(lo, hi, s))(0, N, E).to(torch.int64)
    rvec = (lambda *s: torch.randn(*s, dtype=torch.bfloat16) * 0.05)(E, 3).to(float)
    rn = (torch.linalg.norm(rvec, dim=-1, keepdim=True) + 1e-06).to(float)
    rhat = (rvec / rn).to(float)
    eps = torch.zeros((3, 3, 3), dtype=float)
    eps[0, 1, 2] = eps[1, 2, 0] = eps[2, 0, 1] = 1.0
    eps[0, 2, 1] = eps[2, 1, 0] = eps[1, 0, 2] = -1.0
    return {'x': _w((lambda *s: torch.randn(*s, dtype=torch.bfloat16) * 0.4)(N, 4 * C).to(float)), 'rhat': _w(rhat), 'e_attr': _w((lambda *s: torch.randn(*s, dtype=torch.bfloat16) * 0.4)(E, De).to(float)), 'src': _w(src), 'dst': _w(dst), 'w_rad': _w((lambda *s: torch.randn(*s, dtype=torch.bfloat16) * 0.4)(De, 5 * C).to(float)), 'w_si0': _w((lambda *s: torch.randn(*s, dtype=torch.bfloat16) * 0.4)(2 * C, C).to(float)), 'w_si1': _w((lambda *s: torch.randn(*s, dtype=torch.bfloat16) * 0.05)(3 * C, C).to(float)), 'cg_eps': _w(eps)}

def reference(x, rhat, e_attr, src, dst, w_rad, w_si0, w_si1, cg_eps):
    N = x.shape[0]
    C = w_si0.shape[1]
    E = rhat.shape[0]
    x0 = x[:, :C].clone()
    x1 = x[:, C:].reshape(N, 3, C)
    R = (e_attr @ w_rad).reshape(E, 5, C)
    f0 = x0[src]
    f1 = x1[src]
    Y1 = rhat
    p00_0 = f0 * R[:, 0, :]
    p11_0 = torch.einsum('ejc,ej->ec', f1, Y1) * R[:, 1, :]
    p01_1 = torch.einsum('ec,ej->ejc', f0, Y1) * R[:, 2, :][:, None, :]
    p10_1 = f1 * R[:, 3, :][:, None, :]
    p11_1 = torch.einsum('ijk,ekc,ej->eic', cg_eps, f1, Y1) * R[:, 4, :][:, None, :]
    m0 = torch.concatenate([p00_0, p11_0], axis=-1) @ w_si0
    m1 = torch.einsum('ejp,pc->ejc', torch.concatenate([p01_1, p10_1, p11_1], axis=-1), w_si1)
    agg0 = _segment_sum(m0, dst, N)
    agg1 = _segment_sum(m1.reshape(E, 3 * C), dst, N).reshape(N, 3, C)
    gate = _sigmoid(agg0)
    out1 = agg1 * gate[:, None, :]
    return torch.concatenate([agg0, out1.reshape(N, 3 * C)], axis=-1)
```

```asm
; @launch grid=(256,1,1) block=(768,1,1) lds=162944
.amdgcn_target "amdgcn-amd-amdhsa--gfx950"
.text
.globl gather_scatter__tensor_product_equiv_equiformer__graph_kernel
.p2align 8
.type gather_scatter__tensor_product_equiv_equiformer__graph_kernel,@function
gather_scatter__tensor_product_equiv_equiformer__graph_kernel:
    s_cmp_ge_u32 s2, 256
    s_cbranch_scc1 L_k2_end
    s_load_dwordx2 s[64:65], s[0:1], 32
    s_load_dwordx2 s[68:69], s[0:1], 24
    s_load_dwordx2 s[72:73], s[0:1], 16
    s_load_dwordx2 s[76:77], s[0:1], 8
    s_load_dwordx2 s[40:41], s[0:1], 80
    s_load_dwordx2 s[24:25], s[0:1], 88
    s_load_dwordx2 s[20:21], s[0:1], 0
    s_and_b32 s16, s2, 7
    s_lshl_b32 s16, s16, 5
    s_lshr_b32 s17, s2, 3
    s_add_u32 s16, s16, s17
    v_lshrrev_b32 v7, 6, v0
    v_and_b32 v1, 63, v0
    v_readfirstlane_b32 s3, v7
    s_nop 0
    s_cmp_lg_u32 s3, 10
    s_cbranch_scc1 L_f_nocode
    s_getpc_b64 s[6:7]
L_f_pc:
    s_lshr_b32 s17, s2, 3
    s_lshl_b32 s17, s17, 9
    v_lshl_add_u32 v86, v1, 7, s17
    v_min_u32 v86, L_k2_end-L_f_pc, v86
    v_mov_b32_e64 v87, s7
    v_add_co_u32 v86, vcc, s6, v86
    s_nop 1
    v_addc_co_u32 v87, vcc, 0, v87, vcc
    s_mov_b64 exec, 15
    global_load_dword v94, v[86:87], off
    s_mov_b64 exec, -1
L_f_nocode:
    v_lshlrev_b32 v86, 2, v0
    v_mov_b32_e64 v87, 0
    ds_write_b32 v86, v87 offset:512
    v_lshlrev_b32 v126, 4, v0
    v_lshlrev_b32 v127, 3, v0
    v_mul_u32_u24 v128, 24, v0
    v_lshlrev_b32 v89, 4, v1
    v_mov_b32 v129, 1
    s_movk_i32 s17, 625
    v_cmp_gt_u32 s[46:47], s17, v0
    s_mul_i32 s4, s16, 10000
    s_mul_i32 s5, s16, 5000
    s_mul_i32 s6, s16, 15000
    s_mov_b32 s66, 2560000
    s_mov_b32 s67, 0x00020000
    s_mov_b32 s70, 2560000
    s_mov_b32 s71, 0x00020000
    s_mov_b32 s74, 1280000
    s_mov_b32 s75, 0x00020000
    s_mov_b32 s78, 3840000
    s_mov_b32 s79, 0x00020000
    s_mov_b32 s42, 256
    s_mov_b32 s43, 0x00020000
    s_mov_b32 s26, 8331264
    s_mov_b32 s27, 0x00020000
    s_mov_b32 s22, 5120000
    s_mov_b32 s23, 0x00020000
    s_mov_b32 s30, 5120000
    s_mov_b32 s31, 0x00020000
    s_waitcnt lgkmcnt(0)
    s_cmp_ge_u32 s3, 10
    s_cbranch_scc1 L_f_noload
    s_mov_b64 exec, s[46:47]
    buffer_load_dwordx4 v[38:41], v126, s[64:67], s4 offen nt
    buffer_load_dwordx4 v[42:45], v126, s[68:71], s4 offen nt
    s_mov_b64 exec, -1
L_f_noload:
    s_load_dwordx2 s[28:29], s[0:1], 72
    s_load_dwordx2 s[62:63], s[0:1], 56
    s_load_dwordx4 s[56:59], s[0:1], 40
    s_cmp_lg_u32 s3, 11
    s_cbranch_scc1 L_f_nononce
    s_cmp_lg_u32 s2, 0
    s_cbranch_scc1 L_f_nononce
    s_memrealtime s[6:7]
    v_lshlrev_b32 v86, 2, v1
    s_waitcnt lgkmcnt(0)
    s_or_b32 s6, s6, 1
    v_mov_b32_e64 v87, s6
    buffer_store_dword v87, v86, s[40:43], 0 offen sc1
L_f_nononce:
    s_barrier
    s_cmp_ge_u32 s3, 10
    s_cbranch_scc1 L_f_helper
    s_mov_b64 exec, s[46:47]
    buffer_load_dwordx2 v[46:47], v127, s[72:75], s5 offen nt
    buffer_load_dwordx4 v[50:53], v128, s[76:79], s6 offen nt
    buffer_load_dwordx2 v[54:55], v128, s[76:79], s6 offen offset:16 nt
    s_waitcnt vmcnt(4)
    v_and_b32 v62, 7, v38
    v_bfe_u32 v86, v38, 3, 5
    v_lshlrev_b32_e64 v86, 2, v86
    v_lshl_or_b32 v62, v62, 7, v86
    ds_add_rtn_u32 v66, v62, v129 offset:512
    v_and_b32_e64 v63, 7, v39
    v_bfe_u32 v86, v39, 3, 5
    v_lshlrev_b32_e64 v86, 2, v86
    v_lshl_or_b32 v63, v63, 7, v86
    ds_add_rtn_u32 v67, v63, v129 offset:512
    v_and_b32_e64 v64, 7, v40
    v_bfe_u32 v86, v40, 3, 5
    v_lshlrev_b32_e64 v86, 2, v86
    v_lshl_or_b32 v64, v64, 7, v86
    ds_add_rtn_u32 v68, v64, v129 offset:512
    v_and_b32_e64 v65, 7, v41
    v_bfe_u32 v86, v41, 3, 5
    v_lshlrev_b32_e64 v86, 2, v86
    v_lshl_or_b32 v65, v65, 7, v86
    ds_add_rtn_u32 v69, v65, v129 offset:512
    s_mov_b64 exec, -1
    s_waitcnt lgkmcnt(0)
    s_barrier
    ds_read_b128 v[90:93], v89 offset:512
    s_waitcnt vmcnt(3)
    s_mov_b32 s4, 0x10000000
    s_mov_b32 s5, 1398102
    s_movk_i32 s7, -3072
    s_mov_b32 s19, 3435974
    v_mul_hi_u32_u24 v86, s5, v38
    v_mul_hi_u32_u24 v87, s19, v42
    v_sub_u32 v87, v87, v38
    v_bfe_u32 v87, v87, 1, 2
    v_mad_i32_i24 v88, v86, s7, v38
    v_lshlrev_b32_e64 v86, v86, s4
    v_lshrrev_b32_e64 v88, 8, v88
    v_lshl_or_b32 v86, v42, 9, v86
    v_lshl_or_b32 v87, v88, 2, v87
    v_lshl_or_b32 v72, v87, 2, v86
    v_mul_hi_u32_u24 v86, s5, v39
    v_mul_hi_u32_u24 v87, s19, v43
    v_sub_u32_e64 v87, v87, v39
    v_bfe_u32 v87, v87, 1, 2
    v_mad_i32_i24 v88, v86, s7, v39
    v_lshlrev_b32_e64 v86, v86, s4
    v_lshrrev_b32_e64 v88, 8, v88
    v_lshl_or_b32 v86, v43, 9, v86
    v_lshl_or_b32 v87, v88, 2, v87
    v_lshl_or_b32 v76, v87, 2, v86
    s_waitcnt lgkmcnt(0)
    v_add_u32 v95, v90, v91
    v_add_u32 v96, v95, v92
    v_add_u32 v97, v96, v93
    v_mov_b32 v98, v97
    v_mul_hi_u32_u24 v86, s5, v40
    v_mul_hi_u32_u24_e64 v87, s19, v44
    v_add_u32_dpp v98, v98, v98 row_shr:1 row_mask:0xf bank_mask:0xf bound_ctrl:0
    v_sub_u32_e64 v87, v87, v40
    v_bfe_u32 v87, v87, 1, 2
    v_add_u32_dpp v98, v98, v98 row_shr:2 row_mask:0xf bank_mask:0xf bound_ctrl:0
    v_mad_i32_i24 v88, v86, s7, v40
    v_lshlrev_b32_e64 v86, v86, s4
    v_add_u32_dpp v98, v98, v98 row_shr:4 row_mask:0xf bank_mask:0xf bound_ctrl:0
    v_lshrrev_b32_e64 v88, 8, v88
    v_lshl_or_b32 v86, v44, 9, v86
    v_add_u32_dpp v98, v98, v98 row_shr:8 row_mask:0xf bank_mask:0xf bound_ctrl:0
    v_lshl_or_b32 v87, v88, 2, v87
    v_lshl_or_b32 v80, v87, 2, v86
    v_add_u32_dpp v98, v98, v98 row_bcast:15 row_mask:0xa bank_mask:0xf
    v_mul_hi_u32_u24 v86, s5, v41
    v_mul_hi_u32_u24 v87, s19, v45
    v_add_u32_dpp v98, v98, v98 row_bcast:31 row_mask:0xc bank_mask:0xf
    v_sub_u32 v98, v98, v97
    v_add_u32 v99, v98, v90
    v_add_u32 v100, v98, v95
    v_add_u32 v101, v98, v96
    ds_write_b128 v89, v[98:101] offset:4608
    s_mov_b64 exec, s[46:47]
    ds_read_b32 v62, v62 offset:4608
    ds_read_b32 v63, v63 offset:4608
    ds_read_b32 v64, v64 offset:4608
    ds_read_b32 v65, v65 offset:4608
    v_sub_u32 v87, v87, v41
    v_bfe_u32 v87, v87, 1, 2
    v_mad_i32_i24 v88, v86, s7, v41
    v_lshlrev_b32_e64 v86, v86, s4
    v_lshrrev_b32_e64 v88, 8, v88
    v_lshl_or_b32 v86, v45, 9, v86
    v_lshl_or_b32 v87, v88, 2, v87
    v_lshl_or_b32 v84, v87, 2, v86
    s_movk_i32 s5, 16000
    s_mov_b32 s4, 0xffff0000
    s_waitcnt lgkmcnt(3)
    v_add_u32_e64 v62, v62, v66
    v_mad_u32_u24 v62, v62, 12, s5
    ds_write_b32 v62, v72 offset:8
    s_waitcnt lgkmcnt(3)
    v_add_u32 v63, v63, v67
    v_mad_u32_u24 v63, v63, 12, s5
    ds_write_b32 v63, v76 offset:8
    s_waitcnt lgkmcnt(3)
    v_add_u32 v64, v64, v68
    v_mad_u32_u24 v64, v64, 12, s5
    ds_write_b32 v64, v80 offset:8
    s_waitcnt lgkmcnt(3)
    v_add_u32 v65, v65, v69
    v_mad_u32_u24 v65, v65, 12, s5
    ds_write_b32 v65, v84 offset:8
    s_mov_b64 exec, -1
    s_mov_b32 s64, s58
    s_mov_b32 s65, s59
    s_mov_b32 s66, 16384
    s_mov_b32 s67, 0x00020000
    s_mov_b32 s68, s62
    s_mov_b32 s69, s63
    s_mov_b32 s70, 24576
    s_mov_b32 s71, 0x00020000
    s_mov_b32 s72, s56
    s_mov_b32 s73, s57
    s_mov_b32 s74, 640
    s_mov_b32 s75, 0x00020000
    s_cmp_lt_u32 s3, 4
    s_cselect_b32 s76, s58, s62
    s_cselect_b32 s77, s59, s63
    s_cselect_b32 s78, s66, s70
    s_mov_b32 s79, 0x00020000
    s_cselect_b32 s19, 0, 16384
    s_sub_u32 s19, 12288, s19
    s_lshl_b32 s17, s3, 10
    s_add_u32 s19, s19, s17
    buffer_load_dwordx4 v[106:109], v89, s[64:67], s17 offen
    buffer_load_dwordx4 v[110:113], v89, s[76:79], s19 offen
    s_add_u32 s19, s17, 8192
    buffer_load_dwordx4 v[114:117], v89, s[68:71], s19 offen
    s_add_u32 s19, s17, 20480
    buffer_load_dwordx4 v[118:121], v89, s[68:71], s19 offen
    v_lshrrev_b32 v144, 3, v1
    v_lshlrev_b32 v145, 1, v144
    s_lshl_b32 s19, s3, 4
    buffer_load_ushort v122, v145, s[72:75], s19 offen offset:0
    buffer_load_ushort v123, v145, s[72:75], s19 offen offset:192
    buffer_load_ushort v124, v145, s[72:75], s19 offen offset:384
    buffer_load_ushort v125, v145, s[72:75], s19 offen offset:576
    s_mov_b64 exec, s[46:47]
    s_waitcnt vmcnt(8)
    v_lshlrev_b32 v86, 16, v46
    v_lshlrev_b32 v102, 16, v50
    v_and_b32 v103, s4, v50
    v_lshlrev_b32 v104, 16, v51
    v_mul_f32 v102, v86, v102
    v_mul_f32 v103, v86, v103
    v_mul_f32_e64 v104, v86, v104
    v_cvt_pk_bf16_f32 v70, v86, v102
    v_cvt_pk_bf16_f32 v71, v103, v104
    ds_write2_b32 v62, v70, v71 offset0:0 offset1:1
    v_and_b32 v86, s4, v46
    v_and_b32 v102, s4, v51
    v_lshlrev_b32 v103, 16, v52
    v_and_b32 v104, s4, v52
    v_mul_f32 v102, v86, v102
    v_mul_f32 v103, v86, v103
    v_mul_f32_e64 v104, v86, v104
    v_cvt_pk_bf16_f32 v74, v86, v102
    v_cvt_pk_bf16_f32 v75, v103, v104
    ds_write2_b32 v63, v74, v75 offset0:0 offset1:1
    v_lshlrev_b32 v86, 16, v47
    v_lshlrev_b32 v102, 16, v53
    v_and_b32 v103, s4, v53
    v_lshlrev_b32 v104, 16, v54
    v_mul_f32 v102, v86, v102
    v_mul_f32 v103, v86, v103
    v_mul_f32_e64 v104, v86, v104
    v_cvt_pk_bf16_f32 v78, v86, v102
    v_cvt_pk_bf16_f32 v79, v103, v104
    ds_write2_b32 v64, v78, v79 offset0:0 offset1:1
    v_and_b32 v86, s4, v47
    v_and_b32 v102, s4, v54
    v_lshlrev_b32 v103, 16, v55
    v_and_b32 v104, s4, v55
    v_mul_f32 v102, v86, v102
    v_mul_f32 v103, v86, v103
    v_mul_f32_e64 v104, v86, v104
    v_cvt_pk_bf16_f32 v82, v86, v102
    v_cvt_pk_bf16_f32 v83, v103, v104
    ds_write2_b32 v65, v82, v83 offset0:0 offset1:1
    s_mov_b64 exec, -1
    s_cmp_lg_u32 s3, 0
    s_cbranch_scc1 L_f_nooff
    v_lshl_or_b32 v98, v90, 16, v98
    v_lshl_or_b32 v99, v91, 16, v99
    v_lshl_or_b32 v100, v92, 16, v100
    v_lshl_or_b32 v101, v93, 16, v101
    v_add_u32 v86, 151680, v89
    ds_write_b128 v86, v[98:101]
    v_lshrrev_b32 v86, 1, v89
    v_add_u32 v86, 151680, v86
    ds_read_b64 v[152:153], v86
    ds_read_b64 v[156:157], v86 offset:512
L_f_nooff:
    s_mul_i32 s4, s16, 30080
    s_add_u32 s4, s4, 565248
    s_add_u32 s5, s4, 10240
    s_add_u32 s6, s4, 20480
    s_movk_i32 s17, 600
    v_cmp_gt_u32 s[46:47], s17, v0
    s_setprio 3
    s_waitcnt lgkmcnt(0)
    s_barrier
    ds_read_b128 v[50:53], v126 offset:16000
    ds_read_b128 v[54:57], v126 offset:26240
    ds_read_b128 v[58:61], v126 offset:36480
    s_waitcnt lgkmcnt(2)
    buffer_store_dwordx4 v[50:53], v126, s[24:27], s4 offen sc1
    s_waitcnt lgkmcnt(1)
    buffer_store_dwordx4 v[54:57], v126, s[24:27], s5 offen sc1
    s_waitcnt lgkmcnt(0)
    s_mov_b64 exec, s[46:47]
    buffer_store_dwordx4 v[58:61], v126, s[24:27], s6 offen sc1
    s_mov_b64 exec, -1
    s_setprio 0
    s_branch L_f_join
L_f_helper:
    s_waitcnt lgkmcnt(0)
    s_barrier
    s_and_b32 s4, s2, 63
    s_lshl_b32 s4, s4, 2
    v_mov_b32 v142, 0
    s_mov_b32 s5, 0x40000
    buffer_load_dword v143, v142, s[40:43], s4 offen sc1
    s_mov_b32 s64, s58
    s_mov_b32 s65, s59
    s_mov_b32 s66, 16384
    s_mov_b32 s67, 0x00020000
    s_mov_b32 s68, s62
    s_mov_b32 s69, s63
    s_mov_b32 s70, 24576
    s_mov_b32 s71, 0x00020000
    s_mov_b32 s72, s56
    s_mov_b32 s73, s57
    s_mov_b32 s74, 640
    s_mov_b32 s75, 0x00020000
    s_cmp_lt_u32 s3, 4
    s_cselect_b32 s76, s58, s62
    s_cselect_b32 s77, s59, s63
    s_cselect_b32 s78, s66, s70
    s_mov_b32 s79, 0x00020000
    s_cselect_b32 s19, 0, 16384
    s_sub_u32 s19, 12288, s19
    s_lshl_b32 s17, s3, 10
    s_add_u32 s19, s19, s17
    buffer_load_dwordx4 v[106:109], v89, s[64:67], s17 offen
    buffer_load_dwordx4 v[110:113], v89, s[76:79], s19 offen
    s_add_u32 s19, s17, 8192
    buffer_load_dwordx4 v[114:117], v89, s[68:71], s19 offen
    s_add_u32 s19, s17, 20480
    buffer_load_dwordx4 v[118:121], v89, s[68:71], s19 offen
    v_lshrrev_b32 v144, 3, v1
    v_lshlrev_b32_e64 v145, 1, v144
    s_lshl_b32 s19, s3, 4
    buffer_load_ushort v122, v145, s[72:75], s19 offen offset:0
    buffer_load_ushort v123, v145, s[72:75], s19 offen offset:192
    buffer_load_ushort v124, v145, s[72:75], s19 offen offset:384
    buffer_load_ushort v125, v145, s[72:75], s19 offen offset:576
    s_waitcnt vmcnt(8)
L_f_again:
    v_readfirstlane_b32 s6, v143
    s_nop 0
    s_cmp_lg_u32 s6, 0
    s_cbranch_scc1 L_f_got
    s_sub_u32 s5, s5, 1
    s_cbranch_scc1 L_f_got
    s_sleep 2
    buffer_load_dword v143, v142, s[40:43], s4 offen sc1
    s_waitcnt vmcnt(0)
    s_branch L_f_again
L_f_got:
    v_mov_b32 v142, 150656
    ds_write_b32 v142, v143
    s_waitcnt lgkmcnt(0)
    s_barrier
    s_waitcnt vmcnt(0)
L_f_join:
    v_mov_b32 v86, 150656
    ds_read_b32 v87, v86
    s_mov_b32 s60, 0
    s_add_u32 s38, s3, 4
    s_sub_u32 s17, s38, 12
    s_min_u32 s38, s38, s17
    s_mul_i32 s70, s3, 1398144
    s_lshr_b32 s70, s70, 16
    s_add_u32 s17, s3, 1
    s_mul_i32 s17, s17, 1398144
    s_lshr_b32 s17, s17, 16
    s_sub_u32 s71, s17, s70
    v_add_u32 v39, s70, v1
    v_lshlrev_b32 v40, 11, v39
    v_cmp_gt_u32 vcc, s71, v1
    v_bfrev_b32 v41, -2
    v_lshlrev_b32 v7, 4, v1
    v_cndmask_b32_e64 v40, v41, v40, vcc
    s_mul_i32 s18, s3, 1536
    s_add_u32 s18, s18, 87936
    s_and_b32 s36, s2, 7
    s_mul_i32 s36, s36, 640000
    s_mov_b32 s67, 0x05040100
    s_mov_b32 s68, 0x07060302
    s_mov_b32 s69, 0x7ffe00
    s_mov_b32 s32, 0xff00ff00
    s_mov_b32 s33, 0xff00ff00
    s_waitcnt lgkmcnt(0)
    v_readfirstlane_b32 s35, v87
    v_mov_b32 v82, 0
    v_mov_b32 v83, 0
    v_mov_b32 v84, 0
    v_mov_b32 v85, 0
    v_add_u32 v86, s18, v7
    ds_write_b128 v86, v[82:85]
    s_mov_b32 exec_hi, 0
    ds_write_b128 v86, v[82:85] offset:1024
    s_mov_b32 exec_hi, -1
    v_lshlrev_b32_e64 v87, 4, v0
    v_mov_b32 v78, 0xfffffff
    v_mov_b32 v79, v78
    v_mov_b32 v80, v78
    v_mov_b32_e64 v81, v78
    ds_write_b128 v87, v[78:81] offset:512
    v_cmp_gt_u32 vcc, 200, v0
    s_nop 0
    s_mov_b64 exec, vcc
    ds_write_b128 v87, v[78:81] offset:12800
    s_mov_b64 exec, -1
    s_mov_b32 exec_hi, 0
    ds_write_b128 v7, v[82:85]
    s_mov_b32 exec_hi, -1
    v_mov_b32 v46, v152
    v_mov_b32 v47, s35
    v_mov_b32 v48, v153
    v_mov_b32 v49, s35
    v_mov_b32 v62, v156
    v_mov_b32 v63, s35
    v_mov_b32 v64, v157
    v_mov_b32 v65, s35
    s_lshl_b32 s19, s16, 11
    s_lshl_b32 s17, s16, 3
    v_mov_b32 v66, 0
    v_cmp_gt_u32 s[6:7], s71, v1
    s_mov_b32 s5, 0x40000
    v_lshrrev_b32_e64 v86, 4, v1
    v_bfe_u32 v88, v1, 2, 2
    v_lshl_add_u32 v100, v86, 3, v88
    v_lshlrev_b32 v100, 7, v100
    s_and_b32 s4, s3, 3
    v_xor_b32_e64 v88, s4, v88
    v_lshl_add_u32 v100, v88, 5, v100
    v_and_b32_e64 v88, 3, v1
    v_lshl_add_u32 v100, v88, 3, v100
    s_lshr_b32 s4, s3, 2
    s_lshl_b32 s4, s4, 12
    s_add_u32 s4, s4, 109696
    v_add_u32 v100, s4, v100
    s_lshl_b32 s4, s3, 10
    s_add_u32 s4, s4, 46976
    v_add_u32 v101, s4, v7
    v_and_b32 v138, 7, v1
    v_lshlrev_b32_e64 v138, 2, v138
    v_lshl_add_u32 v138, v144, 7, v138
    v_and_b32_e64 v144, 3, v144
    v_lshl_add_u32 v138, v144, 5, v138
    s_lshl_b32 s4, s3, 10
    s_add_u32 s4, s4, 109696
    v_add_u32 v138, s4, v138
    v_xor_b32 v139, 32, v138
    v_xor_b32 v140, 64, v138
    v_xor_b32 v141, 96, v138
    s_mov_b32 s4, 0xffff0000
    s_mov_b32 s34, 30080
    v_mul_lo_u32 v95, v39, s34
    v_mul_u32_u24_e64 v73, 12, v1
    v_lshl_add_u32 v72, v1, 2, s18
    s_waitcnt vmcnt(0)
    s_barrier
    s_cmp_lg_u32 s3, 0
    s_cbranch_scc1 L_f_noflag
    buffer_store_dwordx4 v[46:49], v7, s[24:27], s19 offen sc1
    buffer_store_dwordx4 v[62:65], v7, s[24:27], s19 offen offset:1024 sc1
L_f_noflag:
    v_lshlrev_b32 v122, 16, v122
    v_lshlrev_b32 v144, 16, v106
    v_lshlrev_b32 v145, 16, v108
    v_and_b32 v148, s4, v106
    v_and_b32_e64 v149, s4, v108
    v_pk_mul_f32 v[144:145], v[144:145], v[122:123] op_sel:[0,0] op_sel_hi:[1,0]
    v_pk_mul_f32 v[148:149], v[148:149], v[122:123] op_sel:[0,0] op_sel_hi:[1,0]
    v_cvt_pk_bf16_f32 v146, v144, v145
    v_cvt_pk_bf16_f32 v150, v148, v149
    ds_write_b32 v138, v146 offset:0
    ds_write_b32 v139, v150 offset:0
    v_lshlrev_b32 v144, 16, v107
    v_lshlrev_b32 v145, 16, v109
    v_and_b32 v148, s4, v107
    v_and_b32 v149, s4, v109
    v_pk_mul_f32 v[144:145], v[144:145], v[122:123] op_sel:[0,0] op_sel_hi:[1,0]
    v_pk_mul_f32 v[148:149], v[148:149], v[122:123] op_sel:[0,0] op_sel_hi:[1,0]
    v_cvt_pk_bf16_f32 v147, v144, v145
    v_cvt_pk_bf16_f32 v151, v148, v149
    ds_write_b32 v140, v147 offset:0
    ds_write_b32 v141, v151 offset:0
    v_lshlrev_b32 v123, 16, v123
    v_lshlrev_b32 v144, 16, v110
    v_lshlrev_b32 v145, 16, v112
    v_and_b32 v148, s4, v110
    v_and_b32_e64 v149, s4, v112
    v_pk_mul_f32 v[144:145], v[144:145], v[122:123] op_sel:[0,1] op_sel_hi:[1,1]
    v_pk_mul_f32 v[148:149], v[148:149], v[122:123] op_sel:[0,1] op_sel_hi:[1,1]
    v_cvt_pk_bf16_f32 v146, v144, v145
    v_cvt_pk_bf16_f32 v150, v148, v149
    ds_write_b32 v138, v146 offset:12288
    ds_write_b32 v139, v150 offset:12288
    v_lshlrev_b32 v144, 16, v111
    v_lshlrev_b32 v145, 16, v113
    v_and_b32 v148, s4, v111
    v_and_b32 v149, s4, v113
    v_pk_mul_f32 v[144:145], v[144:145], v[122:123] op_sel:[0,1] op_sel_hi:[1,1]
    v_pk_mul_f32 v[148:149], v[148:149], v[122:123] op_sel:[0,1] op_sel_hi:[1,1]
    v_cvt_pk_bf16_f32 v147, v144, v145
    v_cvt_pk_bf16_f32 v151, v148, v149
    ds_write_b32 v140, v147 offset:12288
    ds_write_b32 v141, v151 offset:12288
    v_lshlrev_b32 v124, 16, v124
    v_lshlrev_b32 v144, 16, v114
    v_lshlrev_b32 v145, 16, v116
    v_and_b32 v148, s4, v114
    v_and_b32_e64 v149, s4, v116
    v_pk_mul_f32 v[144:145], v[144:145], v[124:125] op_sel:[0,0] op_sel_hi:[1,0]
    v_pk_mul_f32 v[148:149], v[148:149], v[124:125] op_sel:[0,0] op_sel_hi:[1,0]
    v_cvt_pk_bf16_f32 v146, v144, v145
    v_cvt_pk_bf16_f32 v150, v148, v149
    ds_write_b32 v138, v146 offset:24576
    ds_write_b32 v139, v150 offset:24576
    v_lshlrev_b32 v144, 16, v115
    v_lshlrev_b32 v145, 16, v117
    v_and_b32 v148, s4, v115
    v_and_b32 v149, s4, v117
    v_pk_mul_f32 v[144:145], v[144:145], v[124:125] op_sel:[0,0] op_sel_hi:[1,0]
    v_pk_mul_f32 v[148:149], v[148:149], v[124:125] op_sel:[0,0] op_sel_hi:[1,0]
    v_cvt_pk_bf16_f32 v147, v144, v145
    v_cvt_pk_bf16_f32 v151, v148, v149
    ds_write_b32 v140, v147 offset:24576
    ds_write_b32 v141, v151 offset:24576
    s_cmp_ge_u32 s3, 4
    s_cbranch_scc1 L_f_w3
    v_lshlrev_b32 v125, 16, v125
    v_lshlrev_b32 v144, 16, v118
    v_lshlrev_b32 v145, 16, v120
    v_and_b32 v148, s4, v118
    v_and_b32_e64 v149, s4, v120
    v_pk_mul_f32 v[144:145], v[144:145], v[124:125] op_sel:[0,1] op_sel_hi:[1,1]
    v_pk_mul_f32 v[148:149], v[148:149], v[124:125] op_sel:[0,1] op_sel_hi:[1,1]
    v_cvt_pk_bf16_f32 v146, v144, v145
    v_cvt_pk_bf16_f32 v150, v148, v149
    ds_write_b32 v138, v146 offset:36864
    ds_write_b32 v139, v150 offset:36864
    v_lshlrev_b32 v144, 16, v119
    v_lshlrev_b32 v145, 16, v121
    v_and_b32 v148, s4, v119
    v_and_b32 v149, s4, v121
    v_pk_mul_f32 v[144:145], v[144:145], v[124:125] op_sel:[0,1] op_sel_hi:[1,1]
    v_pk_mul_f32 v[148:149], v[148:149], v[124:125] op_sel:[0,1] op_sel_hi:[1,1]
    v_cvt_pk_bf16_f32 v147, v144, v145
    v_cvt_pk_bf16_f32 v151, v148, v149
    ds_write_b32 v140, v147 offset:36864
    ds_write_b32 v141, v151 offset:36864
L_f_w3:
    s_waitcnt lgkmcnt(0)
    s_barrier
    ds_read_b64_tr_b16 v[106:107], v100 offset:0
    ds_read_b64_tr_b16 v[108:109], v100 offset:512
    ds_read_b64_tr_b16 v[110:111], v100 offset:12288
    ds_read_b64_tr_b16 v[112:113], v100 offset:12800
    ds_read_b64_tr_b16 v[114:115], v100 offset:24576
    ds_read_b64_tr_b16 v[116:117], v100 offset:25088
    ds_read_b64_tr_b16 v[118:119], v100 offset:36864
    ds_read_b64_tr_b16 v[120:121], v100 offset:37376
    s_waitcnt lgkmcnt(6)
    ds_write_b128 v101, v[106:109] offset:0
    s_waitcnt lgkmcnt(4)
    ds_write_b128 v101, v[110:113] offset:12288
    s_waitcnt lgkmcnt(2)
    ds_write_b128 v101, v[114:117] offset:24576
    s_cmp_ge_u32 s3, 4
    s_cbranch_scc1 L_f_w4
    s_waitcnt lgkmcnt(0)
    ds_write_b128 v101, v[118:121] offset:36864
L_f_w4:
    s_mov_b64 exec, s[6:7]
    buffer_load_dwordx2 v[66:67], v40, s[24:27], s17 offen sc1
    s_waitcnt vmcnt(0)
L_f_poll:
    v_cmp_ne_u32_e64 vcc, s35, v67
    s_nop 0
    s_and_b64 exec, exec, vcc
    s_cbranch_scc0 L_f_seen
    s_sub_u32 s5, s5, 1
    s_cbranch_scc1 L_f_seen
    s_sleep 2
    buffer_load_dwordx2 v[66:67], v40, s[24:27], s17 offen sc1
    s_waitcnt vmcnt(0)
    s_branch L_f_poll
L_f_seen:
    s_mov_b64 exec, -1
    v_mov_b32 v38, v66
L_k2_round:
    v_lshrrev_b32_e64 v41, 16, v38
    v_and_b32 v66, 0xffff, v38
    v_mov_b32_e64 v40, v41
    v_add_u32_dpp v41, v41, v41 row_shr:1 row_mask:0xf bank_mask:0xf bound_ctrl:0
    s_mul_i32 s17, s60, 288
    s_nop 0
    v_add_u32_dpp v41, v41, v41 row_shr:2 row_mask:0xf bank_mask:0xf bound_ctrl:0
    s_movk_i32 s19, 383
    s_nop 0
    v_add_u32_dpp v41, v41, v41 row_shr:4 row_mask:0xf bank_mask:0xf bound_ctrl:0
    v_add_u32_e64 v66, v66, v40
    s_nop 0
    v_add_u32_dpp v41, v41, v41 row_shr:8 row_mask:0xf bank_mask:0xf bound_ctrl:0
    s_nop 1
    v_add_u32_dpp v41, v41, v41 row_bcast:15 row_mask:0xa bank_mask:0xf
    v_sub_u32 v66, v66, v41
    v_readlane_b32 s58, v41, 31
    v_sub_u32_e64 v41, v41, v40
    v_mad_i32_i24 v66, v66, 12, v95
    v_subrev_u32_e64 v67, s17, v41
    v_med3_i32 v67, v67, 0, s19
    v_lshl_add_u32 v67, v67, 2, s18
    s_mov_b64 exec, s[6:7]
    ds_max_u32 v67, v66
    s_mov_b64 exec, -1
    ds_read_b32 v68, v72 offset:0
    ds_read_b32 v69, v72 offset:256
    ds_read_b32 v70, v72 offset:512
    ds_read_b32 v71, v72 offset:768
    ds_read_b32 v72, v72 offset:1024
    v_mov_b32 v74, v38
    v_mov_b32_e64 v75, v39
    s_sub_u32 s62, s58, s17
    s_min_i32 s62, s62, 288
    s_mul_i32 s17, s17, 12
    s_add_u32 s17, s17, 565248
    s_waitcnt lgkmcnt(1)
    v_max_u32_dpp v68, v68, v68 row_shr:1 row_mask:0xf bank_mask:0xf bound_ctrl:0
    v_max_u32_dpp v69, v69, v69 row_shr:1 row_mask:0xf bank_mask:0xf bound_ctrl:0
    v_max_u32_dpp v70, v70, v70 row_shr:1 row_mask:0xf bank_mask:0xf bound_ctrl:0
    v_max_u32_dpp v71, v71, v71 row_shr:1 row_mask:0xf bank_mask:0xf bound_ctrl:0
    v_max_u32_dpp v68, v68, v68 row_shr:2 row_mask:0xf bank_mask:0xf bound_ctrl:0
    v_max_u32_dpp v69, v69, v69 row_shr:2 row_mask:0xf bank_mask:0xf bound_ctrl:0
    v_max_u32_dpp v70, v70, v70 row_shr:2 row_mask:0xf bank_mask:0xf bound_ctrl:0
    v_max_u32_dpp v71, v71, v71 row_shr:2 row_mask:0xf bank_mask:0xf bound_ctrl:0
    v_max_u32_dpp v68, v68, v68 row_shr:4 row_mask:0xf bank_mask:0xf bound_ctrl:0
    v_max_u32_dpp v69, v69, v69 row_shr:4 row_mask:0xf bank_mask:0xf bound_ctrl:0
    v_max_u32_dpp v70, v70, v70 row_shr:4 row_mask:0xf bank_mask:0xf bound_ctrl:0
    v_max_u32_dpp v71, v71, v71 row_shr:4 row_mask:0xf bank_mask:0xf bound_ctrl:0
    v_max_u32_dpp v68, v68, v68 row_shr:8 row_mask:0xf bank_mask:0xf bound_ctrl:0
    v_max_u32_dpp v69, v69, v69 row_shr:8 row_mask:0xf bank_mask:0xf bound_ctrl:0
    v_max_u32_dpp v70, v70, v70 row_shr:8 row_mask:0xf bank_mask:0xf bound_ctrl:0
    v_max_u32_dpp v71, v71, v71 row_shr:8 row_mask:0xf bank_mask:0xf bound_ctrl:0
    v_max_u32_dpp v68, v68, v68 row_bcast:15 row_mask:0xa bank_mask:0xf
    v_max_u32_dpp v69, v69, v69 row_bcast:15 row_mask:0xa bank_mask:0xf
    v_max_u32_dpp v70, v70, v70 row_bcast:15 row_mask:0xa bank_mask:0xf
    v_max_u32_dpp v71, v71, v71 row_bcast:15 row_mask:0xa bank_mask:0xf
    v_max_u32_dpp v68, v68, v68 row_bcast:31 row_mask:0xc bank_mask:0xf
    v_max_u32_dpp v69, v69, v69 row_bcast:31 row_mask:0xc bank_mask:0xf
    v_max_u32_dpp v70, v70, v70 row_bcast:31 row_mask:0xc bank_mask:0xf
    v_max_u32_dpp v71, v71, v71 row_bcast:31 row_mask:0xc bank_mask:0xf
    v_readlane_b32 s72, v68, 63
    v_readlane_b32 s73, v69, 63
    v_readlane_b32 s74, v70, 63
    v_readlane_b32 s75, v71, 63
    v_add_u32 v68, v68, v73
    s_max_u32 s73, s73, s72
    s_max_u32 s74, s74, s73
    s_max_u32 s75, s75, s74
    s_cmp_le_i32 s62, 256
    s_cbranch_scc1 L_k2_skip4
    s_waitcnt lgkmcnt(0)
    v_max_u32_dpp v72, v72, v72 row_shr:1 row_mask:0xf bank_mask:0xf bound_ctrl:0
    s_nop 1
    v_max_u32_dpp v72, v72, v72 row_shr:2 row_mask:0xf bank_mask:0xf bound_ctrl:0
    s_nop 1
    v_max_u32_dpp v72, v72, v72 row_shr:4 row_mask:0xf bank_mask:0xf bound_ctrl:0
    s_nop 1
    v_max_u32_dpp v72, v72, v72 row_shr:8 row_mask:0xf bank_mask:0xf bound_ctrl:0
    s_nop 1
    v_max_u32_dpp v72, v72, v72 row_bcast:15 row_mask:0xa bank_mask:0xf
    s_nop 1
    v_max_u32_dpp v72, v72, v72 row_bcast:31 row_mask:0xc bank_mask:0xf
    v_max_u32 v72, s75, v72
    v_add_u32_e64 v72, v72, v73
    buffer_load_dwordx3 v[38:40], v72, s[24:27], s17 offen offset:3072 sc1
L_k2_skip4:
    buffer_load_dwordx3 v[22:24], v68, s[24:27], s17 offen offset:0 sc1
    v_max_u32 v69, s72, v69
    v_add_u32 v69, v69, v73
    buffer_load_dwordx3 v[26:28], v69, s[24:27], s17 offen offset:768 sc1
    v_max_u32 v70, s73, v70
    v_add_u32 v70, v70, v73
    buffer_load_dwordx3 v[30:32], v70, s[24:27], s17 offen offset:1536 sc1
    v_max_u32 v71, s74, v71
    v_add_u32 v71, v71, v73
    buffer_load_dwordx3 v[34:36], v71, s[24:27], s17 offen offset:2304 sc1
    v_cmp_gt_i32 s[48:49], s62, v1
    s_sub_u32 s19, s62, 64
    v_cmp_gt_i32 s[50:51], s19, v1
    s_sub_u32 s19, s62, 128
    v_cmp_gt_i32 s[52:53], s19, v1
    s_sub_u32 s19, s62, 192
    v_cmp_gt_i32 s[54:55], s19, v1
    s_sub_u32 s19, s62, 256
    v_cmp_gt_i32 s[56:57], s19, v1
    v_and_b32 v2, 15, v1
    v_lshlrev_b32 v2, 4, v2
    v_and_b32 v6, 3, v1
    v_add_u32 v6, 28, v6
    s_cmp_lg_u32 s60, 0
    s_cbranch_scc1 L_k2_acc
    v_mov_b64 v[102:103], 0
    v_mov_b64 v[104:105], 0
    v_mov_b64 v[106:107], 0
    v_mov_b64 v[108:109], 0
    v_mov_b64 v[110:111], 0
    v_mov_b64 v[112:113], 0
    v_mov_b64 v[114:115], 0
    v_mov_b64 v[116:117], 0
    v_mov_b64 v[118:119], 0
    v_mov_b64 v[120:121], 0
    v_mov_b64 v[122:123], 0
    v_mov_b64 v[124:125], 0
    v_mov_b64 v[126:127], 0
    v_mov_b64 v[128:129], 0
    v_mov_b64 v[130:131], 0
    v_mov_b64 v[132:133], 0
    v_mov_b64 v[134:135], 0
    v_mov_b64 v[136:137], 0
    v_mov_b64 v[138:139], 0
    v_mov_b64 v[140:141], 0
    v_mov_b64 v[142:143], 0
    v_mov_b64 v[144:145], 0
    v_mov_b64 v[146:147], 0
    v_mov_b64 v[148:149], 0
    v_mov_b64 v[150:151], 0
    v_mov_b64 v[152:153], 0
    v_mov_b64 v[154:155], 0
    v_mov_b64 v[156:157], 0
    v_mov_b64 v[158:159], 0
    v_mov_b64 v[160:161], 0
    v_mov_b64 v[162:163], 0
    v_mov_b64 v[164:165], 0
L_k2_acc:
    v_and_b32 v91, 3, v1
    v_cmp_lt_u32 vcc, 0, v91
    v_lshlrev_b32 v67, 2, v1
    v_mov_b32 v66, 192
    v_cndmask_b32 v92, 0, -1, vcc
    v_cmp_lt_u32 vcc, 1, v91
    v_lshrrev_b32 v3, 4, v1
    v_lshlrev_b32_e64 v3, 2, v3
    v_cndmask_b32 v93, 0, -1, vcc
    v_and_b32_e64 v4, 12, v1
    v_lshl_add_u32 v4, v4, 2, v3
    v_mov_b32 v7, v74
    v_mov_b32 v0, v75
    v_mov_b32_e64 v94, 4
    v_mov_b32 v82, 0x100000
    v_mov_b32 v83, v82
    v_mov_b32 v84, v82
    v_mov_b32 v85, v82
    v_mov_b32 v86, v82
    s_waitcnt lgkmcnt(0)
    s_barrier
    s_cmp_le_u32 s58, 288
    s_cbranch_scc1 L_k2_one
    v_mov_b32_e64 v91, s58
    s_mov_b64 exec, 1
    ds_max_u32 v66, v91
    s_mov_b64 exec, -1
L_k2_one:
    v_lshlrev_b32_e64 v43, 7, v1
    s_lshr_b32 s34, s2, 3
    s_mul_i32 s34, s34, 12
    s_add_u32 s34, s34, s3
    s_mul_i32 s17, s34, 1792
    s_add_u32 s17, s17, s36
    s_sub_u32 s37, s17, 5120000
    s_min_u32 s17, s17, s37
    s_mov_b32 exec_lo, 16383
    s_mov_b32 exec_hi, 0
    buffer_load_dword v44, v43, s[20:23], s17 offen
    s_mov_b64 exec, -1
    s_waitcnt vmcnt(4)
    v_and_b32 v68, 0xfc, v24
    s_mov_b64 exec, s[48:49]
    ds_add_rtn_u32 v82, v68, v94 offset:256
    s_mov_b64 exec, -1
    s_waitcnt vmcnt(3)
    v_and_b32 v69, 0xfc, v28
    s_mov_b64 exec, s[50:51]
    ds_add_rtn_u32 v83, v69, v94 offset:256
    s_mov_b64 exec, -1
    s_waitcnt vmcnt(2)
    v_and_b32 v70, 0xfc, v32
    s_mov_b64 exec, s[52:53]
    ds_add_rtn_u32 v84, v70, v94 offset:256
    s_mov_b64 exec, -1
    s_waitcnt vmcnt(1)
    v_and_b32 v71, 0xfc, v36
    s_mov_b64 exec, s[54:55]
    ds_add_rtn_u32 v85, v71, v94 offset:256
    s_mov_b64 exec, -1
    s_cmp_le_i32 s62, 256
    s_cbranch_scc1 L_k2_skip4a
    v_and_b32 v72, 0xfc, v40
    s_mov_b64 exec, s[56:57]
    ds_add_rtn_u32 v86, v72, v94 offset:256
    s_mov_b64 exec, -1
L_k2_skip4a:
    s_waitcnt lgkmcnt(0)
    s_barrier
    ds_read_b32 v88, v67 offset:256
    ds_read_b32 v66, v66
    s_lshl_b32 s19, s38, 2
    s_waitcnt lgkmcnt(1)
    v_and_b32_dpp v91, v88, v92 quad_perm:[0,0,1,2] row_mask:0xf bank_mask:0xf
    v_add_u32_e64 v89, v88, v91
    s_nop 1
    v_and_b32_dpp v91, v89, v93 quad_perm:[0,0,0,1] row_mask:0xf bank_mask:0xf
    v_add_u32 v89, v89, v91
    s_nop 1
    v_mov_b32_dpp v90, v89 quad_perm:[3,3,3,3] row_mask:0xf bank_mask:0xf
    v_add_u32 v91, 127, v90
    v_and_b32 v91, 0xffffff80, v91
    v_sub_u32 v89, v89, v88
    v_sub_u32 v89, v89, v91
    v_mov_b32_e64 v88, v91
    v_add_u32_dpp v91, v91, v91 row_shr:4 row_mask:0xf bank_mask:0xf bound_ctrl:0
    v_readlane_b32 s61, v90, s19
    s_nop 0
    v_add_u32_dpp v91, v91, v91 row_shr:8 row_mask:0xf bank_mask:0xf bound_ctrl:0
    s_nop 1
    v_add_u32_dpp v91, v91, v91 row_bcast:15 row_mask:0xa bank_mask:0xf
    s_nop 1
    v_add_u32_dpp v91, v91, v91 row_bcast:31 row_mask:0xc bank_mask:0xf
    v_add_u32 v89, v89, v91
    v_sub_u32_e64 v88, v91, v88
    s_cmp_le_i32 s62, 256
    s_cbranch_scc1 L_k2_skip4c
    ds_bpermute_b32 v72, v72, v89
L_k2_skip4c:
    ds_bpermute_b32 v68, v68, v89
    ds_bpermute_b32 v69, v69, v89
    ds_bpermute_b32 v70, v70, v89
    ds_bpermute_b32 v71, v71, v89
    v_readlane_b32 s17, v88, s19
    s_cmp_lg_u32 s60, 0
    s_cbranch_scc1 L_k2_havernd
    s_waitcnt lgkmcnt(4)
    v_readfirstlane_b32 s59, v66
L_k2_havernd:
    v_add_u32 v3, s17, v3
    v_add_u32 v4, s17, v4
    s_movk_i32 s19, 16000
    v_lshl_add_u32 v5, v4, 1, s19
    s_lshr_b32 s61, s61, 2
    s_add_u32 s17, s61, 31
    s_lshr_b32 s17, s17, 5
    s_mul_i32 s64, s17, 90
    s_add_u32 s64, s64, 128
    s_lshr_b32 s64, s64, 8
    s_lshl_b32 s64, s64, 5
    s_sub_u32 s64, s61, s64
    s_waitcnt lgkmcnt(3)
    v_add_u32 v68, v68, v82
    ds_write_b32 v68, v24 offset:512
    v_lshlrev_b32_e64 v82, 1, v68
    ds_write_b64 v82, v[22:23] offset:16000
    s_waitcnt lgkmcnt(4)
    v_add_u32 v69, v69, v83
    ds_write_b32 v69, v28 offset:512
    v_lshlrev_b32_e64 v83, 1, v69
    ds_write_b64 v83, v[26:27] offset:16000
    s_waitcnt lgkmcnt(5)
    v_add_u32 v70, v70, v84
    ds_write_b32 v70, v32 offset:512
    v_lshlrev_b32_e64 v84, 1, v70
    ds_write_b64 v84, v[30:31] offset:16000
    s_waitcnt lgkmcnt(6)
    v_add_u32 v71, v71, v85
    ds_write_b32 v71, v36 offset:512
    v_lshlrev_b32_e64 v85, 1, v71
    ds_write_b64 v85, v[34:35] offset:16000
    s_cmp_le_i32 s62, 256
    s_cbranch_scc1 L_k2_skip4b
    v_add_u32 v72, v72, v86
    ds_write_b32 v72, v40 offset:512
    v_lshlrev_b32_e64 v86, 1, v72
    ds_write_b64 v86, v[38:39] offset:16000
L_k2_skip4b:
    s_waitcnt lgkmcnt(0)
    s_barrier
    s_setprio 2
    ds_read2_b32 v[14:15], v3 offset0:128 offset1:132
    ds_read2_b32 v[16:17], v3 offset0:136 offset1:140
    ds_read2_b32 v[18:19], v3 offset0:144 offset1:148
    ds_read2_b32 v[20:21], v3 offset0:152 offset1:156
    ds_read2_b32 v[8:9], v4 offset0:128 offset1:144
    v_add_u32 v3, 128, v3
    v_add_u32 v4, 128, v4
    s_mov_b32 s62, s61
    s_mov_b32 s63, 1
    s_cmp_ge_u32 s61, 32
    s_cbranch_scc1 L_k2_full
    s_waitcnt vmcnt(0) lgkmcnt(0)
    v_mov_b32 v38, 0
    v_mov_b32 v39, 0
    v_mov_b32 v40, 0
    v_mov_b32 v41, 0
    v_mov_b32 v42, 0
    v_mov_b32 v43, 0
    v_mov_b32 v44, 0
    v_mov_b32 v45, 0
    v_mov_b32 v46, 0
    v_mov_b32 v47, 0
    v_mov_b32 v48, 0
    v_mov_b32 v49, 0
    v_mov_b32 v50, 0
    v_mov_b32 v51, 0
    v_mov_b32 v52, 0
    v_mov_b32 v53, 0
    v_mov_b32 v54, 0
    v_mov_b32 v55, 0
    v_mov_b32 v56, 0
    v_mov_b32 v57, 0
    v_mov_b32 v58, 0
    v_mov_b32 v59, 0
    v_mov_b32 v60, 0
    v_mov_b32 v61, 0
    v_mov_b32 v62, 0
    v_mov_b32 v63, 0
    v_mov_b32 v64, 0
    v_mov_b32 v65, 0
    v_mov_b32 v66, 0
    v_mov_b32 v67, 0
    v_mov_b32 v68, 0
    v_mov_b32 v69, 0
    v_mov_b32 v70, 0
    v_mov_b32 v71, 0
    v_mov_b32 v72, 0
    v_mov_b32 v73, 0
    v_mov_b32 v74, 0
    v_mov_b32 v75, 0
    v_mov_b32 v76, 0
    v_mov_b32 v77, 0
    v_mov_b32 v78, 0
    v_mov_b32 v79, 0
    v_mov_b32 v80, 0
    v_mov_b32 v81, 0
    v_mov_b32 v82, 0
    v_mov_b32 v83, 0
    v_mov_b32 v84, 0
    v_mov_b32 v85, 0
    v_mov_b32 v86, 0
    v_mov_b32 v87, 0
    v_mov_b32 v88, 0
    v_mov_b32 v89, 0
    v_mov_b32 v90, 0
    v_mov_b32 v91, 0
    v_mov_b32 v92, 0
    v_mov_b32 v93, 0
    v_mov_b32 v94, 0
    v_mov_b32 v95, 0
    v_mov_b32 v96, 0
    v_mov_b32 v97, 0
    v_mov_b32 v98, 0
    v_mov_b32 v99, 0
    v_mov_b32 v100, 0
    v_mov_b32 v101, 0
    v_and_or_b32 v14, v14, s69, v2
    v_and_or_b32 v15, v15, s69, v2
    v_and_or_b32 v16, v16, s69, v2
    v_and_or_b32 v17, v17, s69, v2
    v_and_or_b32 v18, v18, s69, v2
    v_and_or_b32 v19, v19, s69, v2
    v_and_or_b32 v20, v20, s69, v2
    v_and_or_b32 v21, v21, s69, v2
    v_bfe_i32 v8, v8, v6, 1
    v_and_b32_e64 v8, v8, v5
    v_bfe_i32 v9, v9, v6, 1
    v_and_b32_e64 v9, v9, v5
    v_add_u32 v5, 256, v5
    ds_read_b64_tr_b16 v[10:11], v8
    ds_read_b64_tr_b16 v[12:13], v9 offset:128
    s_cmp_eq_u32 s61, 0
    s_cbranch_scc1 L_k2_last
    buffer_load_dwordx4 v[38:41], v14, s[20:23], 0 offen offset:0
    s_cmp_le_i32 s62, 4
    s_cbranch_scc1 L_p0_1
    buffer_load_dwordx4 v[42:45], v15, s[20:23], 0 offen offset:0
    s_cmp_le_i32 s62, 8
    s_cbranch_scc1 L_p0_2
    buffer_load_dwordx4 v[46:49], v16, s[20:23], 0 offen offset:0
    s_cmp_le_i32 s62, 12
    s_cbranch_scc1 L_p0_3
    buffer_load_dwordx4 v[50:53], v17, s[20:23], 0 offen offset:0
    s_cmp_le_i32 s62, 16
    s_cbranch_scc1 L_p0_4
    buffer_load_dwordx4 v[54:57], v18, s[20:23], 0 offen offset:0
    s_cmp_le_i32 s62, 20
    s_cbranch_scc1 L_p0_5
    buffer_load_dwordx4 v[58:61], v19, s[20:23], 0 offen offset:0
    s_cmp_le_i32 s62, 24
    s_cbranch_scc1 L_p0_6
    buffer_load_dwordx4 v[62:65], v20, s[20:23], 0 offen offset:0
    s_cmp_le_i32 s62, 28
    s_cbranch_scc1 L_p0_7
    buffer_load_dwordx4 v[66:69], v21, s[20:23], 0 offen offset:0
L_p0_1:
L_p0_2:
L_p0_3:
L_p0_4:
L_p0_5:
L_p0_6:
L_p0_7:
    buffer_load_dwordx4 v[70:73], v14, s[20:23], 0 offen offset:256
    s_cmp_le_i32 s62, 4
    s_cbranch_scc1 L_p1_1
    buffer_load_dwordx4 v[74:77], v15, s[20:23], 0 offen offset:256
    s_cmp_le_i32 s62, 8
    s_cbranch_scc1 L_p1_2
    buffer_load_dwordx4 v[78:81], v16, s[20:23], 0 offen offset:256
    s_cmp_le_i32 s62, 12
    s_cbranch_scc1 L_p1_3
    buffer_load_dwordx4 v[82:85], v17, s[20:23], 0 offen offset:256
    s_cmp_le_i32 s62, 16
    s_cbranch_scc1 L_p1_4
    buffer_load_dwordx4 v[86:89], v18, s[20:23], 0 offen offset:256
    s_cmp_le_i32 s62, 20
    s_cbranch_scc1 L_p1_5
    buffer_load_dwordx4 v[90:93], v19, s[20:23], 0 offen offset:256
    s_cmp_le_i32 s62, 24
    s_cbranch_scc1 L_p1_6
    buffer_load_dwordx4 v[94:97], v20, s[20:23], 0 offen offset:256
    s_cmp_le_i32 s62, 28
    s_cbranch_scc1 L_p1_7
    buffer_load_dwordx4 v[98:101], v21, s[20:23], 0 offen offset:256
L_p1_1:
L_p1_2:
L_p1_3:
L_p1_4:
L_p1_5:
L_p1_6:
L_p1_7:
    s_branch L_k2_last
L_k2_full:
    s_waitcnt lgkmcnt(0)
    v_and_or_b32 v14, v14, s69, v2
    v_and_or_b32 v15, v15, s69, v2
    v_and_or_b32 v16, v16, s69, v2
    v_and_or_b32 v17, v17, s69, v2
    v_and_or_b32 v18, v18, s69, v2
    v_and_or_b32 v19, v19, s69, v2
    v_and_or_b32 v20, v20, s69, v2
    v_and_or_b32 v21, v21, s69, v2
    v_bfe_i32 v8, v8, v6, 1
    v_and_b32_e64 v8, v8, v5
    v_bfe_i32 v9, v9, v6, 1
    v_and_b32_e64 v9, v9, v5
    v_add_u32 v5, 256, v5
    ds_read_b64_tr_b16 v[10:11], v8
    ds_read_b64_tr_b16 v[12:13], v9 offset:128
    buffer_load_dwordx4 v[38:41], v14, s[20:23], 0 offen offset:0
    buffer_load_dwordx4 v[42:45], v15, s[20:23], 0 offen offset:0
    buffer_load_dwordx4 v[46:49], v16, s[20:23], 0 offen offset:0
    buffer_load_dwordx4 v[50:53], v17, s[20:23], 0 offen offset:0
    buffer_load_dwordx4 v[54:57], v18, s[20:23], 0 offen offset:0
    buffer_load_dwordx4 v[58:61], v19, s[20:23], 0 offen offset:0
    buffer_load_dwordx4 v[62:65], v20, s[20:23], 0 offen offset:0
    buffer_load_dwordx4 v[66:69], v21, s[20:23], 0 offen offset:0
    buffer_load_dwordx4 v[70:73], v14, s[20:23], 0 offen offset:256
    buffer_load_dwordx4 v[74:77], v15, s[20:23], 0 offen offset:256
    buffer_load_dwordx4 v[78:81], v16, s[20:23], 0 offen offset:256
    buffer_load_dwordx4 v[82:85], v17, s[20:23], 0 offen offset:256
    buffer_load_dwordx4 v[86:89], v18, s[20:23], 0 offen offset:256
    buffer_load_dwordx4 v[90:93], v19, s[20:23], 0 offen offset:256
    buffer_load_dwordx4 v[94:97], v20, s[20:23], 0 offen offset:256
    buffer_load_dwordx4 v[98:101], v21, s[20:23], 0 offen offset:256
    ds_read2_b32 v[14:15], v3 offset0:128 offset1:132
    ds_read2_b32 v[16:17], v3 offset0:136 offset1:140
    ds_read2_b32 v[18:19], v3 offset0:144 offset1:148
    ds_read2_b32 v[20:21], v3 offset0:152 offset1:156
    ds_read2_b32 v[8:9], v4 offset0:128 offset1:144
    v_add_u32 v3, 128, v3
    v_add_u32 v4, 128, v4
    s_sub_u32 s62, s62, 32
    s_cmp_lt_i32 s62, 32
    s_cbranch_scc1 L_k2_tail
    s_nop 0
L_k2_loop:
    s_cmp_lg_u32 s62, s64
    s_cbranch_scc1 L_k2_pr1
    s_setprio 1
L_k2_pr1:
    s_waitcnt vmcnt(8) lgkmcnt(0)
    v_perm_b32 v22, v42, v38, s67
    v_perm_b32 v23, v50, v46, s67
    v_perm_b32 v24, v58, v54, s67
    v_perm_b32 v25, v66, v62, s67
    v_perm_b32 v26, v42, v38, s68
    v_perm_b32 v27, v50, v46, s68
    v_perm_b32 v28, v58, v54, s68
    v_perm_b32 v29, v66, v62, s68
    v_mfma_f32_16x16x32_bf16 v[102:105], v[10:13], v[22:25], v[102:105]
    v_perm_b32 v30, v43, v39, s67
    v_perm_b32 v31, v51, v47, s67
    v_perm_b32 v32, v59, v55, s67
    v_perm_b32 v33, v67, v63, s67
    v_mfma_f32_16x16x32_bf16 v[106:109], v[10:13], v[26:29], v[106:109]
    v_perm_b32 v34, v43, v39, s68
    v_perm_b32 v35, v51, v47, s68
    v_perm_b32 v36, v59, v55, s68
    v_perm_b32 v37, v67, v63, s68
    v_mfma_f32_16x16x32_bf16 v[110:113], v[10:13], v[30:33], v[110:113]
    v_perm_b32 v22, v44, v40, s67
    v_perm_b32 v23, v52, v48, s67
    v_perm_b32 v24, v60, v56, s67
    v_perm_b32 v25, v68, v64, s67
    v_mfma_f32_16x16x32_bf16 v[114:117], v[10:13], v[34:37], v[114:117]
    v_perm_b32 v26, v44, v40, s68
    v_perm_b32 v27, v52, v48, s68
    v_perm_b32 v28, v60, v56, s68
    v_perm_b32 v29, v68, v64, s68
    v_mfma_f32_16x16x32_bf16 v[118:121], v[10:13], v[22:25], v[118:121]
    v_perm_b32 v30, v45, v41, s67
    v_perm_b32 v31, v53, v49, s67
    v_perm_b32 v32, v61, v57, s67
    v_perm_b32 v33, v69, v65, s67
    v_mfma_f32_16x16x32_bf16 v[122:125], v[10:13], v[26:29], v[122:125]
    v_perm_b32 v34, v45, v41, s68
    v_perm_b32 v35, v53, v49, s68
    v_perm_b32 v36, v61, v57, s68
    v_perm_b32 v37, v69, v65, s68
    v_mfma_f32_16x16x32_bf16 v[126:129], v[10:13], v[30:33], v[126:129]
    v_and_or_b32 v14, v14, s69, v2
    v_and_or_b32 v15, v15, s69, v2
    v_and_or_b32 v16, v16, s69, v2
    v_and_or_b32 v17, v17, s69, v2
    v_and_or_b32 v18, v18, s69, v2
    v_and_or_b32 v19, v19, s69, v2
    v_and_or_b32 v20, v20, s69, v2
    v_and_or_b32 v21, v21, s69, v2
    v_bfe_i32 v8, v8, v6, 1
    v_and_b32_e64 v8, v8, v5
    v_bfe_i32 v9, v9, v6, 1
    v_and_b32_e64 v9, v9, v5
    v_add_u32 v5, 256, v5
    v_mfma_f32_16x16x32_bf16 v[130:133], v[10:13], v[34:37], v[130:133]
    buffer_load_dwordx4 v[38:41], v14, s[20:23], 0 offen offset:0
    buffer_load_dwordx4 v[42:45], v15, s[20:23], 0 offen offset:0
    buffer_load_dwordx4 v[46:49], v16, s[20:23], 0 offen offset:0
    buffer_load_dwordx4 v[50:53], v17, s[20:23], 0 offen offset:0
    buffer_load_dwordx4 v[54:57], v18, s[20:23], 0 offen offset:0
    buffer_load_dwordx4 v[58:61], v19, s[20:23], 0 offen offset:0
    buffer_load_dwordx4 v[62:65], v20, s[20:23], 0 offen offset:0
    buffer_load_dwordx4 v[66:69], v21, s[20:23], 0 offen offset:0
    s_sub_u32 s62, s62, 32
    s_waitcnt vmcnt(8)
    v_perm_b32 v22, v74, v70, s67
    v_perm_b32 v23, v82, v78, s67
    v_perm_b32 v24, v90, v86, s67
    v_perm_b32 v25, v98, v94, s67
    v_perm_b32 v26, v74, v70, s68
    v_perm_b32 v27, v82, v78, s68
    v_perm_b32 v28, v90, v86, s68
    v_perm_b32 v29, v98, v94, s68
    v_mfma_f32_16x16x32_bf16 v[134:137], v[10:13], v[22:25], v[134:137]
    v_perm_b32 v30, v75, v71, s67
    v_perm_b32 v31, v83, v79, s67
    v_perm_b32 v32, v91, v87, s67
    v_perm_b32 v33, v99, v95, s67
    v_mfma_f32_16x16x32_bf16 v[138:141], v[10:13], v[26:29], v[138:141]
    v_perm_b32 v34, v75, v71, s68
    v_perm_b32 v35, v83, v79, s68
    v_perm_b32 v36, v91, v87, s68
    v_perm_b32 v37, v99, v95, s68
    v_mfma_f32_16x16x32_bf16 v[142:145], v[10:13], v[30:33], v[142:145]
    v_perm_b32 v22, v76, v72, s67
    v_perm_b32 v23, v84, v80, s67
    v_perm_b32 v24, v92, v88, s67
    v_perm_b32 v25, v100, v96, s67
    v_mfma_f32_16x16x32_bf16 v[146:149], v[10:13], v[34:37], v[146:149]
    v_perm_b32 v26, v76, v72, s68
    v_perm_b32 v27, v84, v80, s68
    v_perm_b32 v28, v92, v88, s68
    v_perm_b32 v29, v100, v96, s68
    v_mfma_f32_16x16x32_bf16 v[150:153], v[10:13], v[22:25], v[150:153]
    v_perm_b32 v30, v77, v73, s67
    v_perm_b32 v31, v85, v81, s67
    v_perm_b32 v32, v93, v89, s67
    v_perm_b32 v33, v101, v97, s67
    v_mfma_f32_16x16x32_bf16 v[154:157], v[10:13], v[26:29], v[154:157]
    v_perm_b32 v34, v77, v73, s68
    v_perm_b32 v35, v85, v81, s68
    v_perm_b32 v36, v93, v89, s68
    v_perm_b32 v37, v101, v97, s68
    buffer_load_dwordx4 v[70:73], v14, s[20:23], 0 offen offset:256
    v_mfma_f32_16x16x32_bf16 v[158:161], v[10:13], v[30:33], v[158:161]
    buffer_load_dwordx4 v[74:77], v15, s[20:23], 0 offen offset:256
    v_mfma_f32_16x16x32_bf16 v[162:165], v[10:13], v[34:37], v[162:165]
    buffer_load_dwordx4 v[78:81], v16, s[20:23], 0 offen offset:256
    buffer_load_dwordx4 v[82:85], v17, s[20:23], 0 offen offset:256
    buffer_load_dwordx4 v[86:89], v18, s[20:23], 0 offen offset:256
    buffer_load_dwordx4 v[90:93], v19, s[20:23], 0 offen offset:256
    buffer_load_dwordx4 v[94:97], v20, s[20:23], 0 offen offset:256
    buffer_load_dwordx4 v[98:101], v21, s[20:23], 0 offen offset:256
    ds_read_b64_tr_b16 v[10:11], v8
    ds_read_b64_tr_b16 v[12:13], v9 offset:128
    ds_read2_b32 v[14:15], v3 offset0:128 offset1:132
    ds_read2_b32 v[16:17], v3 offset0:136 offset1:140
    ds_read2_b32 v[18:19], v3 offset0:144 offset1:148
    ds_read2_b32 v[20:21], v3 offset0:152 offset1:156
    ds_read2_b32 v[8:9], v4 offset0:128 offset1:144
    v_add_u32 v3, 128, v3
    v_add_u32 v4, 128, v4
    s_cmp_ge_i32 s62, 32
    s_cbranch_scc1 L_k2_loop
L_k2_tail:
    s_setprio 1
    s_cmp_le_i32 s62, 0
    s_cbranch_scc1 L_k2_last
    s_waitcnt vmcnt(8)
    v_perm_b32 v22, v42, v38, s67
    v_perm_b32 v23, v50, v46, s67
    v_perm_b32 v24, v58, v54, s67
    v_perm_b32 v25, v66, v62, s67
    v_perm_b32 v26, v42, v38, s68
    v_perm_b32 v27, v50, v46, s68
    v_perm_b32 v28, v58, v54, s68
    v_perm_b32 v29, v66, v62, s68
    s_waitcnt lgkmcnt(0)
    v_mfma_f32_16x16x32_bf16 v[102:105], v[10:13], v[22:25], v[102:105]
    v_perm_b32 v30, v43, v39, s67
    v_perm_b32 v31, v51, v47, s67
    v_perm_b32 v32, v59, v55, s67
    v_perm_b32 v33, v67, v63, s67
    v_mfma_f32_16x16x32_bf16 v[106:109], v[10:13], v[26:29], v[106:109]
    v_perm_b32 v34, v43, v39, s68
    v_perm_b32 v35, v51, v47, s68
    v_perm_b32 v36, v59, v55, s68
    v_perm_b32 v37, v67, v63, s68
    v_mfma_f32_16x16x32_bf16 v[110:113], v[10:13], v[30:33], v[110:113]
    v_perm_b32 v22, v44, v40, s67
    v_perm_b32 v23, v52, v48, s67
    v_perm_b32 v24, v60, v56, s67
    v_perm_b32 v25, v68, v64, s67
    v_mfma_f32_16x16x32_bf16 v[114:117], v[10:13], v[34:37], v[114:117]
    v_perm_b32 v26, v44, v40, s68
    v_perm_b32 v27, v52, v48, s68
    v_perm_b32 v28, v60, v56, s68
    v_perm_b32 v29, v68, v64, s68
    v_mfma_f32_16x16x32_bf16 v[118:121], v[10:13], v[22:25], v[118:121]
    v_perm_b32 v30, v45, v41, s67
    v_perm_b32 v31, v53, v49, s67
    v_perm_b32 v32, v61, v57, s67
    v_perm_b32 v33, v69, v65, s67
    v_mfma_f32_16x16x32_bf16 v[122:125], v[10:13], v[26:29], v[122:125]
    v_perm_b32 v34, v45, v41, s68
    v_perm_b32 v35, v53, v49, s68
    v_perm_b32 v36, v61, v57, s68
    v_perm_b32 v37, v69, v65, s68
    v_mfma_f32_16x16x32_bf16 v[126:129], v[10:13], v[30:33], v[126:129]
    v_and_or_b32 v14, v14, s69, v2
    v_and_or_b32 v15, v15, s69, v2
    v_and_or_b32 v16, v16, s69, v2
    v_and_or_b32 v17, v17, s69, v2
    v_and_or_b32 v18, v18, s69, v2
    v_and_or_b32 v19, v19, s69, v2
    v_and_or_b32 v20, v20, s69, v2
    v_and_or_b32 v21, v21, s69, v2
    v_bfe_i32 v8, v8, v6, 1
    v_and_b32 v8, v8, v5
    v_bfe_i32 v9, v9, v6, 1
    v_and_b32_e64 v9, v9, v5
    v_add_u32 v5, 256, v5
    v_mfma_f32_16x16x32_bf16 v[130:133], v[10:13], v[34:37], v[130:133]
    buffer_load_dwordx4 v[38:41], v14, s[20:23], 0 offen offset:0
    s_cmp_le_i32 s62, 4
    s_cbranch_scc1 L_t0_1
    buffer_load_dwordx4 v[42:45], v15, s[20:23], 0 offen offset:0
    s_cmp_le_i32 s62, 8
    s_cbranch_scc1 L_t0_2
    buffer_load_dwordx4 v[46:49], v16, s[20:23], 0 offen offset:0
    s_cmp_le_i32 s62, 12
    s_cbranch_scc1 L_t0_3
    buffer_load_dwordx4 v[50:53], v17, s[20:23], 0 offen offset:0
    s_cmp_le_i32 s62, 16
    s_cbranch_scc1 L_t0_4
    buffer_load_dwordx4 v[54:57], v18, s[20:23], 0 offen offset:0
    s_cmp_le_i32 s62, 20
    s_cbranch_scc1 L_t0_5
    buffer_load_dwordx4 v[58:61], v19, s[20:23], 0 offen offset:0
    s_cmp_le_i32 s62, 24
    s_cbranch_scc1 L_t0_6
    buffer_load_dwordx4 v[62:65], v20, s[20:23], 0 offen offset:0
    s_cmp_le_i32 s62, 28
    s_cbranch_scc1 L_t0_7
    buffer_load_dwordx4 v[66:69], v21, s[20:23], 0 offen offset:0
    s_waitcnt vmcnt(8)
    s_branch L_t0_done
L_t0_1:
    s_waitcnt vmcnt(1)
    s_branch L_t0_done
L_t0_2:
    s_waitcnt vmcnt(2)
    s_branch L_t0_done
L_t0_3:
    s_waitcnt vmcnt(3)
    s_branch L_t0_done
L_t0_4:
    s_waitcnt vmcnt(4)
    s_branch L_t0_done
L_t0_5:
    s_waitcnt vmcnt(5)
    s_branch L_t0_done
L_t0_6:
    s_waitcnt vmcnt(6)
    s_branch L_t0_done
L_t0_7:
    s_waitcnt vmcnt(7)
L_t0_done:
    v_perm_b32 v22, v74, v70, s67
    v_perm_b32 v23, v82, v78, s67
    v_perm_b32 v24, v90, v86, s67
    v_perm_b32 v25, v98, v94, s67
    v_perm_b32 v26, v74, v70, s68
    v_perm_b32 v27, v82, v78, s68
    v_perm_b32 v28, v90, v86, s68
    v_perm_b32 v29, v98, v94, s68
    v_mfma_f32_16x16x32_bf16 v[134:137], v[10:13], v[22:25], v[134:137]
    v_perm_b32 v30, v75, v71, s67
    v_perm_b32 v31, v83, v79, s67
    v_perm_b32 v32, v91, v87, s67
    v_perm_b32 v33, v99, v95, s67
    v_mfma_f32_16x16x32_bf16 v[138:141], v[10:13], v[26:29], v[138:141]
    v_perm_b32 v34, v75, v71, s68
    v_perm_b32 v35, v83, v79, s68
    v_perm_b32 v36, v91, v87, s68
    v_perm_b32 v37, v99, v95, s68
    v_mfma_f32_16x16x32_bf16 v[142:145], v[10:13], v[30:33], v[142:145]
    v_perm_b32 v22, v76, v72, s67
    v_perm_b32 v23, v84, v80, s67
    v_perm_b32 v24, v92, v88, s67
    v_perm_b32 v25, v100, v96, s67
    v_mfma_f32_16x16x32_bf16 v[146:149], v[10:13], v[34:37], v[146:149]
    v_perm_b32 v26, v76, v72, s68
    v_perm_b32 v27, v84, v80, s68
    v_perm_b32 v28, v92, v88, s68
    v_perm_b32 v29, v100, v96, s68
    v_mfma_f32_16x16x32_bf16 v[150:153], v[10:13], v[22:25], v[150:153]
    v_perm_b32 v30, v77, v73, s67
    v_perm_b32 v31, v85, v81, s67
    v_perm_b32 v32, v93, v89, s67
    v_perm_b32 v33, v101, v97, s67
    v_mfma_f32_16x16x32_bf16 v[154:157], v[10:13], v[26:29], v[154:157]
    v_perm_b32 v34, v77, v73, s68
    v_perm_b32 v35, v85, v81, s68
    v_perm_b32 v36, v93, v89, s68
    v_perm_b32 v37, v101, v97, s68
    v_mfma_f32_16x16x32_bf16 v[158:161], v[10:13], v[30:33], v[158:161]
    s_nop 0
    v_mfma_f32_16x16x32_bf16 v[162:165], v[10:13], v[34:37], v[162:165]
    buffer_load_dwordx4 v[70:73], v14, s[20:23], 0 offen offset:256
    s_cmp_le_i32 s62, 4
    s_cbranch_scc1 L_t1_1
    buffer_load_dwordx4 v[74:77], v15, s[20:23], 0 offen offset:256
    s_cmp_le_i32 s62, 8
    s_cbranch_scc1 L_t1_2
    buffer_load_dwordx4 v[78:81], v16, s[20:23], 0 offen offset:256
    s_cmp_le_i32 s62, 12
    s_cbranch_scc1 L_t1_3
    buffer_load_dwordx4 v[82:85], v17, s[20:23], 0 offen offset:256
    s_cmp_le_i32 s62, 16
    s_cbranch_scc1 L_t1_4
    buffer_load_dwordx4 v[86:89], v18, s[20:23], 0 offen offset:256
    s_cmp_le_i32 s62, 20
    s_cbranch_scc1 L_t1_5
    buffer_load_dwordx4 v[90:93], v19, s[20:23], 0 offen offset:256
    s_cmp_le_i32 s62, 24
    s_cbranch_scc1 L_t1_6
    buffer_load_dwordx4 v[94:97], v20, s[20:23], 0 offen offset:256
    s_cmp_le_i32 s62, 28
    s_cbranch_scc1 L_t1_7
    buffer_load_dwordx4 v[98:101], v21, s[20:23], 0 offen offset:256
L_t1_1:
L_t1_2:
L_t1_3:
L_t1_4:
L_t1_5:
L_t1_6:
L_t1_7:
    ds_read_b64_tr_b16 v[10:11], v8
    ds_read_b64_tr_b16 v[12:13], v9 offset:128
L_k2_last:
    s_waitcnt lgkmcnt(0)
    s_and_b32 s41, s3, 3
    s_and_b32 s40, s38, 12
    v_lshrrev_b32 v20, 4, v1
    v_and_b32_e64 v21, 15, v1
    v_bfe_u32 v14, v1, 3, 1
    v_cvt_f32_u32 v14, v14
    s_min_u32 s17, s38, 4
    s_mul_i32 s19, s38, 3
    s_add_u32 s17, s17, s19
    s_mul_i32 s17, s17, 1568
    s_add_u32 s17, s17, 87936
    s_movk_i32 s19, 1568
    v_lshl_add_u32 v15, v21, 4, s17
    v_mad_u32_u24 v15, v20, s19, v15
    s_min_u32 s17, s40, 4
    s_mul_i32 s46, s40, 3
    s_add_u32 s17, s17, s46
    s_mul_i32 s17, s17, 1568
    s_add_u32 s17, s17, 87936
    v_lshl_add_u32 v16, v20, 4, s17
    v_mad_u32_u24 v16, v21, s19, v16
    s_cmp_eq_u32 s40, 0
    s_cselect_b32 s19, 0, -1568
    v_lshrrev_b32 v18, 2, v21
    v_mad_i32_i24 v16, v18, s19, v16
    s_lshl_b32 s19, s41, 3
    s_lshr_b32 s17, 0x8060400, s19
    s_and_b32 s17, s17, 0xff
    s_lshl_b32 s17, s17, 7
    v_add_u32_e64 v3, s17, v16
    s_lshr_b32 s17, 0x3020105, s19
    s_and_b32 s17, s17, 0xff
    s_lshl_b32 s17, s17, 7
    v_add_u32 v4, s17, v16
    s_lshr_b32 s17, 0x7090b00, s19
    s_and_b32 s17, s17, 0xff
    s_lshl_b32 s17, s17, 7
    v_add_u32 v5, s17, v16
    s_min_u32 s17, s41, 1
    s_lshl_b32 s17, s17, 14
    s_add_u32 s17, s17, 46976
    v_lshl_add_u32 v17, v1, 4, s17
    s_lshl_b32 s17, s40, 10
    s_add_u32 s17, s17, 150656
    v_lshl_add_u32 v16, v1, 4, s17
    s_lshl_b32 s17, s40, 1
    s_add_u32 s17, s17, 208
    v_mov_b32 v19, s17
    v_lshlrev_b32 v18, 17, v20
    v_lshl_add_u32 v18, v21, 3, v18
    s_lshl_b32 s42, s40, 17
    s_lshl_b32 s17, s2, 9
    s_add_u32 s42, s42, s17
    s_lshl_b32 s17, s41, 7
    s_add_u32 s42, s42, s17
    s_add_u32 s43, s42, 1572864
    s_add_u32 s44, s42, 3145728
    s_add_u32 s45, s42, 4718592
    s_cmp_lt_u32 s38, 4
    s_cselect_b32 s46, -1, 0xffff
    s_add_u32 s17, s61, 31
    s_and_b32 s17, s17, 31
    s_cmp_lt_u32 s17, 4
    s_cbranch_scc1 L_lw1
    s_cmp_lt_u32 s17, 8
    s_cbranch_scc1 L_lw2
    s_cmp_lt_u32 s17, 12
    s_cbranch_scc1 L_lw3
    s_cmp_lt_u32 s17, 16
    s_cbranch_scc1 L_lw4
    s_cmp_lt_u32 s17, 20
    s_cbranch_scc1 L_lw5
    s_cmp_lt_u32 s17, 24
    s_cbranch_scc1 L_lw6
    s_cmp_lt_u32 s17, 28
    s_cbranch_scc1 L_lw7
    s_waitcnt vmcnt(8)
    s_branch L_lw0
L_lw1:
    s_waitcnt vmcnt(1)
    s_branch L_lw0
L_lw2:
    s_waitcnt vmcnt(2)
    s_branch L_lw0
L_lw3:
    s_waitcnt vmcnt(3)
    s_branch L_lw0
L_lw4:
    s_waitcnt vmcnt(4)
    s_branch L_lw0
L_lw5:
    s_waitcnt vmcnt(5)
    s_branch L_lw0
L_lw6:
    s_waitcnt vmcnt(6)
    s_branch L_lw0
L_lw7:
    s_waitcnt vmcnt(7)
L_lw0:
    v_perm_b32 v22, v42, v38, s67
    v_perm_b32 v23, v50, v46, s67
    v_perm_b32 v24, v58, v54, s67
    v_perm_b32 v25, v66, v62, s67
    v_perm_b32 v26, v42, v38, s68
    v_perm_b32 v27, v50, v46, s68
    v_perm_b32 v28, v58, v54, s68
    v_perm_b32 v29, v66, v62, s68
    v_mfma_f32_16x16x32_bf16 v[102:105], v[10:13], v[22:25], v[102:105]
    v_perm_b32 v30, v43, v39, s67
    v_perm_b32 v31, v51, v47, s67
    v_perm_b32 v32, v59, v55, s67
    v_perm_b32 v33, v67, v63, s67
    v_mfma_f32_16x16x32_bf16 v[106:109], v[10:13], v[26:29], v[106:109]
    v_perm_b32 v34, v43, v39, s68
    v_perm_b32 v35, v51, v47, s68
    v_perm_b32 v36, v59, v55, s68
    v_perm_b32 v37, v67, v63, s68
    v_mfma_f32_16x16x32_bf16 v[110:113], v[10:13], v[30:33], v[110:113]
    v_perm_b32 v22, v44, v40, s67
    v_perm_b32 v23, v52, v48, s67
    v_perm_b32 v24, v60, v56, s67
    v_perm_b32 v25, v68, v64, s67
    v_mfma_f32_16x16x32_bf16 v[114:117], v[10:13], v[34:37], v[114:117]
    v_perm_b32 v26, v44, v40, s68
    v_perm_b32 v27, v52, v48, s68
    v_perm_b32 v28, v60, v56, s68
    v_perm_b32 v29, v68, v64, s68
    v_mfma_f32_16x16x32_bf16 v[118:121], v[10:13], v[22:25], v[118:121]
    v_perm_b32 v30, v45, v41, s67
    v_perm_b32 v31, v53, v49, s67
    v_perm_b32 v32, v61, v57, s67
    v_perm_b32 v33, v69, v65, s67
    v_mfma_f32_16x16x32_bf16 v[122:125], v[10:13], v[26:29], v[122:125]
    v_perm_b32 v34, v45, v41, s68
    v_perm_b32 v35, v53, v49, s68
    v_perm_b32 v36, v61, v57, s68
    v_perm_b32 v37, v69, v65, s68
    v_mfma_f32_16x16x32_bf16 v[126:129], v[10:13], v[30:33], v[126:129]
    s_nop 0
    v_mfma_f32_16x16x32_bf16 v[130:133], v[10:13], v[34:37], v[130:133]
    ds_read_b128 v[38:41], v17 offset:0
    ds_read_b128 v[42:45], v17 offset:1024
    ds_read_b128 v[46:49], v17 offset:2048
    ds_read_b128 v[50:53], v17 offset:3072
    ds_read_b128 v[54:57], v17 offset:4096
    ds_read_b128 v[58:61], v17 offset:5120
    ds_read_b128 v[62:65], v17 offset:6144
    ds_read_b128 v[66:69], v17 offset:7168
    s_waitcnt vmcnt(0)
    v_perm_b32 v22, v74, v70, s67
    v_perm_b32 v23, v82, v78, s67
    v_perm_b32 v24, v90, v86, s67
    v_perm_b32 v25, v98, v94, s67
    v_perm_b32 v26, v74, v70, s68
    v_perm_b32 v27, v82, v78, s68
    v_perm_b32 v28, v90, v86, s68
    v_perm_b32 v29, v98, v94, s68
    v_mfma_f32_16x16x32_bf16 v[134:137], v[10:13], v[22:25], v[134:137]
    v_perm_b32 v30, v75, v71, s67
    v_perm_b32 v31, v83, v79, s67
    v_perm_b32 v32, v91, v87, s67
    v_perm_b32 v33, v99, v95, s67
    v_mfma_f32_16x16x32_bf16 v[138:141], v[10:13], v[26:29], v[138:141]
    v_perm_b32 v34, v75, v71, s68
    v_perm_b32 v35, v83, v79, s68
    v_perm_b32 v36, v91, v87, s68
    v_perm_b32 v37, v99, v95, s68
    v_mfma_f32_16x16x32_bf16 v[142:145], v[10:13], v[30:33], v[142:145]
    v_perm_b32 v22, v76, v72, s67
    v_perm_b32 v23, v84, v80, s67
    v_perm_b32 v24, v92, v88, s67
    v_perm_b32 v25, v100, v96, s67
    v_mfma_f32_16x16x32_bf16 v[146:149], v[10:13], v[34:37], v[146:149]
    v_perm_b32 v26, v76, v72, s68
    v_perm_b32 v27, v84, v80, s68
    v_perm_b32 v28, v92, v88, s68
    v_perm_b32 v29, v100, v96, s68
    v_mfma_f32_16x16x32_bf16 v[150:153], v[10:13], v[22:25], v[150:153]
    v_perm_b32 v30, v77, v73, s67
    v_perm_b32 v31, v85, v81, s67
    v_perm_b32 v32, v93, v89, s67
    v_perm_b32 v33, v101, v97, s67
    v_mfma_f32_16x16x32_bf16 v[154:157], v[10:13], v[26:29], v[154:157]
    v_perm_b32 v34, v77, v73, s68
    v_perm_b32 v35, v85, v81, s68
    v_perm_b32 v36, v93, v89, s68
    v_perm_b32 v37, v101, v97, s68
    v_mfma_f32_16x16x32_bf16 v[158:161], v[10:13], v[30:33], v[158:161]
    s_nop 0
    v_mfma_f32_16x16x32_bf16 v[162:165], v[10:13], v[34:37], v[162:165]
    s_setprio 0
    s_add_u32 s60, s60, 1
    s_mul_i32 s17, s60, 288
    s_cmp_ge_u32 s17, s59
    s_cbranch_scc1 L_k2_epi
    s_waitcnt vmcnt(0) lgkmcnt(0)
    s_barrier
    v_mov_b32 v38, v7
    v_mov_b32 v39, v0
    s_lshl_b32 s17, s3, 6
    v_add_u32 v0, s17, v1
    v_lshlrev_b32 v7, 4, v1
    v_mov_b32 v82, 0
    v_mov_b32 v83, 0
    v_mov_b32 v84, 0
    v_mov_b32 v85, 0
    v_add_u32 v86, s18, v7
    ds_write_b128 v86, v[82:85]
    s_mov_b32 exec_hi, 0
    ds_write_b128 v86, v[82:85] offset:1024
    s_mov_b32 exec_hi, -1
    v_lshlrev_b32_e64 v87, 4, v0
    v_mov_b32 v78, 0xfffffff
    v_mov_b32 v79, v78
    v_mov_b32 v80, v78
    v_mov_b32_e64 v81, v78
    ds_write_b128 v87, v[78:81] offset:512
    v_cmp_gt_u32 vcc, 200, v0
    s_nop 0
    s_mov_b64 exec, vcc
    ds_write_b128 v87, v[78:81] offset:12800
    s_mov_b64 exec, -1
    s_mov_b32 s34, 30080
    v_mul_lo_u32 v95, v39, s34
    v_mul_u32_u24 v73, 12, v1
    v_lshl_add_u32 v72, v1, 2, s18
    s_mov_b32 exec_lo, 0xffff
    s_mov_b32 exec_hi, 0
    ds_write_b128 v7, v[82:85] offset:256
    s_mov_b64 exec, -1
    s_waitcnt lgkmcnt(0)
    s_barrier
    s_branch L_k2_round
L_k2_epi:
    ds_read_b128 v[70:73], v17 offset:8192
    ds_read_b128 v[74:77], v17 offset:9216
    ds_read_b128 v[78:81], v17 offset:10240
    ds_read_b128 v[82:85], v17 offset:11264
    ds_read_b128 v[86:89], v17 offset:12288
    ds_read_b128 v[90:93], v17 offset:13312
    ds_read_b128 v[94:97], v17 offset:14336
    ds_read_b128 v[98:101], v17 offset:15360
    s_mov_b32 exec_hi, s46
    v_cvt_pk_bf16_f32 v26, v102, v106
    v_cvt_pk_bf16_f32 v27, v110, v114
    v_cvt_pk_bf16_f32 v28, v118, v122
    v_cvt_pk_bf16_f32 v29, v126, v130
    ds_write_b128 v15, v[26:29] offset:0
    v_cvt_pk_bf16_f32 v30, v134, v138
    v_cvt_pk_bf16_f32 v31, v142, v146
    v_cvt_pk_bf16_f32 v32, v150, v154
    v_cvt_pk_bf16_f32 v33, v158, v162
    ds_write_b128 v15, v[30:33] offset:256
    v_add_f32_dpp v22, v136, v137 row_ror:8 row_mask:0xf bank_mask:0xf
    v_sub_f32_dpp v23, v135, v104 row_ror:8 row_mask:0xf bank_mask:0xf
    v_subrev_f32_dpp v136, v137, v136 row_ror:8 row_mask:0xf bank_mask:0xf
    v_fma_f32 v103, v22, v14, v103
    v_fma_f32 v105, -v135, v14, v105
    v_cndmask_b32 v104, v104, v23, s[32:33]
    v_add_f32_dpp v24, v140, v141 row_ror:8 row_mask:0xf bank_mask:0xf
    v_sub_f32_dpp v25, v139, v108 row_ror:8 row_mask:0xf bank_mask:0xf
    v_subrev_f32_dpp v140, v141, v140 row_ror:8 row_mask:0xf bank_mask:0xf
    v_fma_f32 v107, v24, v14, v107
    v_fma_f32 v109, -v139, v14, v109
    v_cndmask_b32 v108, v108, v25, s[32:33]
    v_add_f32_dpp v22, v144, v145 row_ror:8 row_mask:0xf bank_mask:0xf
    v_sub_f32_dpp v23, v143, v112 row_ror:8 row_mask:0xf bank_mask:0xf
    v_subrev_f32_dpp v144, v145, v144 row_ror:8 row_mask:0xf bank_mask:0xf
    v_fma_f32 v111, v22, v14, v111
    v_fma_f32 v113, -v143, v14, v113
    v_cndmask_b32 v112, v112, v23, s[32:33]
    v_add_f32_dpp v24, v148, v149 row_ror:8 row_mask:0xf bank_mask:0xf
    v_sub_f32_dpp v25, v147, v116 row_ror:8 row_mask:0xf bank_mask:0xf
    v_subrev_f32_dpp v148, v149, v148 row_ror:8 row_mask:0xf bank_mask:0xf
    v_fma_f32 v115, v24, v14, v115
    v_fma_f32 v117, -v147, v14, v117
    v_cndmask_b32 v116, v116, v25, s[32:33]
    v_add_f32_dpp v22, v152, v153 row_ror:8 row_mask:0xf bank_mask:0xf
    v_sub_f32_dpp v23, v151, v120 row_ror:8 row_mask:0xf bank_mask:0xf
    v_subrev_f32_dpp v152, v153, v152 row_ror:8 row_mask:0xf bank_mask:0xf
    v_fma_f32 v119, v22, v14, v119
    v_fma_f32 v121, -v151, v14, v121
    v_cndmask_b32 v120, v120, v23, s[32:33]
    v_add_f32_dpp v24, v156, v157 row_ror:8 row_mask:0xf bank_mask:0xf
    v_sub_f32_dpp v25, v155, v124 row_ror:8 row_mask:0xf bank_mask:0xf
    v_subrev_f32_dpp v156, v157, v156 row_ror:8 row_mask:0xf bank_mask:0xf
    v_fma_f32 v123, v24, v14, v123
    v_fma_f32 v125, -v155, v14, v125
    v_cndmask_b32 v124, v124, v25, s[32:33]
    v_add_f32_dpp v22, v160, v161 row_ror:8 row_mask:0xf bank_mask:0xf
    v_sub_f32_dpp v23, v159, v128 row_ror:8 row_mask:0xf bank_mask:0xf
    v_subrev_f32_dpp v160, v161, v160 row_ror:8 row_mask:0xf bank_mask:0xf
    v_fma_f32 v127, v22, v14, v127
    v_fma_f32 v129, -v159, v14, v129
    v_cndmask_b32 v128, v128, v23, s[32:33]
    v_add_f32_dpp v24, v164, v165 row_ror:8 row_mask:0xf bank_mask:0xf
    v_sub_f32_dpp v25, v163, v132 row_ror:8 row_mask:0xf bank_mask:0xf
    v_subrev_f32_dpp v164, v165, v164 row_ror:8 row_mask:0xf bank_mask:0xf
    v_fma_f32 v131, v24, v14, v131
    v_fma_f32 v133, -v163, v14, v133
    v_cndmask_b32 v132, v132, v25, s[32:33]
    v_cvt_pk_bf16_f32 v26, v103, v107
    v_cvt_pk_bf16_f32 v27, v111, v115
    v_cvt_pk_bf16_f32 v28, v119, v123
    v_cvt_pk_bf16_f32 v29, v127, v131
    ds_write_b128 v15, v[26:29] offset:512
    v_cvt_pk_bf16_f32 v30, v104, v108
    v_cvt_pk_bf16_f32 v31, v112, v116
    v_cvt_pk_bf16_f32 v32, v120, v124
    v_cvt_pk_bf16_f32 v33, v128, v132
    ds_write_b128 v15, v[30:33] offset:768
    v_cvt_pk_bf16_f32 v26, v105, v109
    v_cvt_pk_bf16_f32 v27, v113, v117
    v_cvt_pk_bf16_f32 v28, v121, v125
    v_cvt_pk_bf16_f32 v29, v129, v133
    ds_write_b128 v15, v[26:29] offset:1024
    v_cvt_pk_bf16_f32 v30, v136, v140
    v_cvt_pk_bf16_f32 v31, v144, v148
    v_cvt_pk_bf16_f32 v32, v152, v156
    v_cvt_pk_bf16_f32 v33, v160, v164
    ds_write_b128 v15, v[30:33] offset:1280
    v_mov_b32 v22, 1
    s_mov_b64 exec, 1
    ds_add_u32 v19, v22
    s_mov_b64 exec, -1
    s_mov_b32 s19, 0xbfb8aa3b
    s_mov_b32 s18, s19
L_k2_wait1:
    ds_read_b32 v23, v19
    ds_read_b128 v[102:105], v3 offset:0
    ds_read_b128 v[106:109], v3 offset:64
    ds_read_b128 v[110:113], v4 offset:0
    ds_read_b128 v[114:117], v4 offset:64
    ds_read_b128 v[118:121], v5 offset:0
    ds_read_b128 v[122:125], v5 offset:64
    s_waitcnt lgkmcnt(6)
    v_readfirstlane_b32 s17, v23
    s_nop 0
    s_cmp_ge_u32 s17, 4
    s_cbranch_scc1 L_k2_go1
    s_waitcnt lgkmcnt(0)
    s_cmp_ge_u32 s3, 8
    s_cbranch_scc1 L_k2_wait1
L_k2_spin1:
    s_sleep 1
    ds_read_b32 v23, v19
    s_waitcnt lgkmcnt(0)
    v_readfirstlane_b32 s17, v23
    s_nop 0
    s_cmp_ge_u32 s17, 4
    s_cbranch_scc0 L_k2_spin1
    s_branch L_k2_wait1
L_k2_go1:
    s_cmp_eq_u32 s41, 0
    s_cbranch_scc1 L_k2_x
    ds_read_b128 v[142:145], v17 offset:16384
    ds_read_b128 v[146:149], v17 offset:17408
    ds_read_b128 v[150:153], v17 offset:18432
    ds_read_b128 v[154:157], v17 offset:19456
    ds_read_b128 v[158:161], v17 offset:20480
    ds_read_b128 v[162:165], v17 offset:21504
    ds_read_b128 v[10:13], v17 offset:22528
    ds_read_b128 v[34:37], v17 offset:23552
    s_waitcnt lgkmcnt(13)
    v_mfma_f32_16x16x32_bf16 v[126:129], v[102:105], v[38:41], 0
    v_mfma_f32_16x16x32_bf16 v[130:133], v[102:105], v[42:45], 0
    v_mfma_f32_16x16x32_bf16 v[134:137], v[102:105], v[46:49], 0
    v_mfma_f32_16x16x32_bf16 v[138:141], v[102:105], v[50:53], 0
    s_waitcnt lgkmcnt(12)
    v_mfma_f32_16x16x32_bf16 v[126:129], v[106:109], v[54:57], v[126:129]
    v_mfma_f32_16x16x32_bf16 v[130:133], v[106:109], v[58:61], v[130:133]
    v_mfma_f32_16x16x32_bf16 v[134:137], v[106:109], v[62:65], v[134:137]
    v_mfma_f32_16x16x32_bf16 v[138:141], v[106:109], v[66:69], v[138:141]
    s_waitcnt lgkmcnt(11)
    v_mfma_f32_16x16x32_bf16 v[126:129], v[110:113], v[70:73], v[126:129]
    v_mfma_f32_16x16x32_bf16 v[130:133], v[110:113], v[74:77], v[130:133]
    v_mfma_f32_16x16x32_bf16 v[134:137], v[110:113], v[78:81], v[134:137]
    v_mfma_f32_16x16x32_bf16 v[138:141], v[110:113], v[82:85], v[138:141]
    s_waitcnt lgkmcnt(10)
    v_mfma_f32_16x16x32_bf16 v[126:129], v[114:117], v[86:89], v[126:129]
    v_mfma_f32_16x16x32_bf16 v[130:133], v[114:117], v[90:93], v[130:133]
    v_mfma_f32_16x16x32_bf16 v[134:137], v[114:117], v[94:97], v[134:137]
    v_mfma_f32_16x16x32_bf16 v[138:141], v[114:117], v[98:101], v[138:141]
    s_waitcnt lgkmcnt(4)
    v_mfma_f32_16x16x32_bf16 v[126:129], v[118:121], v[142:145], v[126:129]
    v_mfma_f32_16x16x32_bf16 v[130:133], v[118:121], v[146:149], v[130:133]
    v_mfma_f32_16x16x32_bf16 v[134:137], v[118:121], v[150:153], v[134:137]
    v_mfma_f32_16x16x32_bf16 v[138:141], v[118:121], v[154:157], v[138:141]
    s_waitcnt lgkmcnt(0)
    v_mfma_f32_16x16x32_bf16 v[126:129], v[122:125], v[158:161], v[126:129]
    v_mfma_f32_16x16x32_bf16 v[130:133], v[122:125], v[162:165], v[130:133]
    v_mfma_f32_16x16x32_bf16 v[134:137], v[122:125], v[10:13], v[134:137]
    v_mfma_f32_16x16x32_bf16 v[138:141], v[122:125], v[34:37], v[138:141]
L_k2_wait2:
    ds_read_b32 v23, v19 offset:4
    ds_read_b128 v[38:41], v16 offset:0
    ds_read_b128 v[42:45], v16 offset:1024
    ds_read_b128 v[46:49], v16 offset:2048
    ds_read_b128 v[50:53], v16 offset:3072
    s_waitcnt lgkmcnt(4)
    v_readfirstlane_b32 s17, v23
    s_nop 0
    s_cmp_lg_u32 s17, 0
    s_cbranch_scc1 L_k2_go2
    s_waitcnt lgkmcnt(0)
    s_cmp_ge_u32 s3, 8
    s_cbranch_scc1 L_k2_wait2
L_k2_spin2:
    s_sleep 1
    ds_read_b32 v23, v19 offset:4
    s_waitcnt lgkmcnt(0)
    v_readfirstlane_b32 s17, v23
    s_nop 0
    s_cmp_lg_u32 s17, 0
    s_cbranch_scc0 L_k2_spin2
    s_branch L_k2_wait2
L_k2_go2:
    s_waitcnt lgkmcnt(3)
    v_pk_mul_f32 v[126:127], v[38:39], v[126:127]
    v_pk_mul_f32 v[128:129], v[40:41], v[128:129]
    s_waitcnt lgkmcnt(2)
    v_pk_mul_f32 v[130:131], v[42:43], v[130:131]
    v_pk_mul_f32 v[132:133], v[44:45], v[132:133]
    s_waitcnt lgkmcnt(1)
    v_pk_mul_f32 v[134:135], v[46:47], v[134:135]
    v_pk_mul_f32 v[136:137], v[48:49], v[136:137]
    s_waitcnt lgkmcnt(0)
    v_pk_mul_f32 v[138:139], v[50:51], v[138:139]
    v_pk_mul_f32 v[140:141], v[52:53], v[140:141]
    v_cvt_pk_bf16_f32 v54, v126, v130
    v_cvt_pk_bf16_f32 v55, v134, v138
    buffer_store_dwordx2 v[54:55], v18, s[28:31], s42 offen nt
    v_cvt_pk_bf16_f32 v56, v127, v131
    v_cvt_pk_bf16_f32 v57, v135, v139
    buffer_store_dwordx2 v[56:57], v18, s[28:31], s43 offen nt
    v_cvt_pk_bf16_f32 v58, v128, v132
    v_cvt_pk_bf16_f32 v59, v136, v140
    buffer_store_dwordx2 v[58:59], v18, s[28:31], s44 offen nt
    v_cvt_pk_bf16_f32 v60, v129, v133
    v_cvt_pk_bf16_f32 v61, v137, v141
    buffer_store_dwordx2 v[60:61], v18, s[28:31], s45 offen nt
    s_branch L_k2_fin
L_k2_x:
    s_waitcnt lgkmcnt(0)
    v_mfma_f32_16x16x32_bf16 v[126:129], v[102:105], v[38:41], 0
    v_mfma_f32_16x16x32_bf16 v[126:129], v[106:109], v[54:57], v[126:129]
    v_mfma_f32_16x16x32_bf16 v[126:129], v[110:113], v[70:73], v[126:129]
    v_mfma_f32_16x16x32_bf16 v[126:129], v[114:117], v[86:89], v[126:129]
    v_mfma_f32_16x16x32_bf16 v[130:133], v[102:105], v[42:45], 0
    v_mfma_f32_16x16x32_bf16 v[130:133], v[106:109], v[58:61], v[130:133]
    v_mfma_f32_16x16x32_bf16 v[130:133], v[110:113], v[74:77], v[130:133]
    v_mfma_f32_16x16x32_bf16 v[130:133], v[114:117], v[90:93], v[130:133]
    v_mfma_f32_16x16x32_bf16 v[134:137], v[102:105], v[46:49], 0
    v_mfma_f32_16x16x32_bf16 v[134:137], v[106:109], v[62:65], v[134:137]
    v_mfma_f32_16x16x32_bf16 v[134:137], v[110:113], v[78:81], v[134:137]
    s_nop 0
    v_pk_mul_f32 v[142:143], v[126:127], s[18:19]
    v_pk_mul_f32 v[144:145], v[128:129], s[18:19]
    v_mfma_f32_16x16x32_bf16 v[134:137], v[114:117], v[94:97], v[134:137]
    v_exp_f32 v142, v142
    v_exp_f32_e64 v143, v143
    v_mfma_f32_16x16x32_bf16 v[138:141], v[102:105], v[50:53], 0
    v_exp_f32 v144, v144
    v_exp_f32 v145, v145
    v_mfma_f32_16x16x32_bf16 v[138:141], v[106:109], v[66:69], v[138:141]
    v_pk_add_f32 v[142:143], v[142:143], 1.0 op_sel_hi:[1,0]
    v_pk_add_f32 v[144:145], v[144:145], 1.0 op_sel_hi:[1,0]
    v_mfma_f32_16x16x32_bf16 v[138:141], v[110:113], v[82:85], v[138:141]
    v_rcp_f32 v142, v142
    v_rcp_f32 v143, v143
    v_mfma_f32_16x16x32_bf16 v[138:141], v[114:117], v[98:101], v[138:141]
    v_rcp_f32 v144, v144
    v_rcp_f32_e64 v145, v145
    s_nop 0
    ds_write_b128 v16, v[142:145] offset:0
    v_pk_mul_f32 v[146:147], v[130:131], s[18:19]
    v_pk_mul_f32 v[148:149], v[132:133], s[18:19]
    v_exp_f32 v146, v146
    v_exp_f32 v147, v147
    v_exp_f32 v148, v148
    v_exp_f32 v149, v149
    v_pk_add_f32 v[146:147], v[146:147], 1.0 op_sel_hi:[1,0]
    v_pk_add_f32 v[148:149], v[148:149], 1.0 op_sel_hi:[1,0]
    v_rcp_f32 v146, v146
    v_rcp_f32 v147, v147
    v_rcp_f32 v148, v148
    v_rcp_f32_e64 v149, v149
    s_nop 0
    ds_write_b128 v16, v[146:149] offset:1024
    v_pk_mul_f32 v[150:151], v[134:135], s[18:19]
    v_pk_mul_f32 v[152:153], v[136:137], s[18:19]
    v_exp_f32 v150, v150
    v_exp_f32 v151, v151
    v_exp_f32 v152, v152
    v_exp_f32 v153, v153
    v_pk_add_f32 v[150:151], v[150:151], 1.0 op_sel_hi:[1,0]
    v_pk_add_f32 v[152:153], v[152:153], 1.0 op_sel_hi:[1,0]
    v_rcp_f32 v150, v150
    v_rcp_f32 v151, v151
    v_rcp_f32 v152, v152
    v_rcp_f32_e64 v153, v153
    s_nop 0
    ds_write_b128 v16, v[150:153] offset:2048
    v_pk_mul_f32 v[154:155], v[138:139], s[18:19]
    v_pk_mul_f32 v[156:157], v[140:141], s[18:19]
    v_exp_f32 v154, v154
    v_exp_f32 v155, v155
    v_exp_f32 v156, v156
    v_exp_f32 v157, v157
    v_pk_add_f32 v[154:155], v[154:155], 1.0 op_sel_hi:[1,0]
    v_pk_add_f32 v[156:157], v[156:157], 1.0 op_sel_hi:[1,0]
    v_rcp_f32 v154, v154
    v_rcp_f32 v155, v155
    v_rcp_f32 v156, v156
    v_rcp_f32_e64 v157, v157
    s_nop 0
    ds_write_b128 v16, v[154:157] offset:3072
    s_mov_b64 exec, 1
    ds_write_b32 v19, v22 offset:4
    s_mov_b64 exec, -1
    v_cvt_pk_bf16_f32 v54, v126, v130
    v_cvt_pk_bf16_f32 v55, v134, v138
    buffer_store_dwordx2 v[54:55], v18, s[28:31], s42 offen nt
    v_cvt_pk_bf16_f32 v56, v127, v131
    v_cvt_pk_bf16_f32 v57, v135, v139
    buffer_store_dwordx2 v[56:57], v18, s[28:31], s43 offen nt
    v_cvt_pk_bf16_f32 v58, v128, v132
    v_cvt_pk_bf16_f32 v59, v136, v140
    buffer_store_dwordx2 v[58:59], v18, s[28:31], s44 offen nt
    v_cvt_pk_bf16_f32 v60, v129, v133
    v_cvt_pk_bf16_f32 v61, v137, v141
    buffer_store_dwordx2 v[60:61], v18, s[28:31], s45 offen nt
L_k2_fin:
L_k2_end:
    s_endpgm
.section .rodata,"a"
.p2align 6
.amdhsa_kernel gather_scatter__tensor_product_equiv_equiformer__graph_kernel
  .amdhsa_next_free_vgpr 166
  .amdhsa_next_free_sgpr 80
  .amdhsa_accum_offset 168
  .amdhsa_group_segment_fixed_size 0
  .amdhsa_kernarg_size 96
  .amdhsa_user_sgpr_count 2
  .amdhsa_user_sgpr_kernarg_segment_ptr 1
  .amdhsa_system_sgpr_workgroup_id_x 1
  .amdhsa_float_denorm_mode_32 3
.end_amdhsa_kernel
```
